```python
import torch

def _softmax(x, axis=-1):
    return torch.softmax(x, dim=axis)
def _gelu(x):
    return torch.nn.functional.gelu(x, approximate="tanh")
def _silu(x):
    return torch.nn.functional.silu(x)
def _sigmoid(x):
    return torch.sigmoid(x)
def _layernorm(x, axis=-1, eps=1e-5):
    m = x.mean(dim=axis, keepdim=True)
    v = x.var(dim=axis, keepdim=True, unbiased=False)
    return (x - m) / torch.sqrt(v + eps)
def _scatter_add(tgt, idx, src, axis=0):
    return tgt.clone().index_add_(axis, idx, src)
def _segment_sum(src, seg, n):
    out = torch.zeros((n,) + src.shape[1:], dtype=src.dtype)
    return out.index_add_(0, seg, src)
def _pad(x, pw):
    flat = tuple(v for pair in reversed(pw) for v in pair)
    return torch.nn.functional.pad(x, flat)

kernel_name = 'gated_mix__sliding_local_dilated__softmax_full_mha__prompt'

def setup_inputs():

    _w = (lambda a: (lambda t: t.to(torch.bfloat16) if t.is_floating_point() else t)(torch.as_tensor(a)))
    def _A_setup():
        B, S, D = 1, 2048, 640
        return {
            "x": _w((lambda *s: torch.randn(*s, dtype=torch.bfloat16) * 0.05)(B, S, D)),
            "wqkv": _w((lambda *s: torch.randn(*s, dtype=torch.bfloat16) * 1.6)(D, 3 * D)),
            "wo": _w((lambda *s: torch.randn(*s, dtype=torch.bfloat16) * 0.05)(D, D)),
        }
    _A_in = _A_setup()

    def _B_setup():
        B, S, D = 1, 2048, 640
        return {
            "x": _w((lambda *s: torch.randn(*s, dtype=torch.bfloat16) * 0.05)(B, S, D)),
            "wqkv": _w((lambda *s: torch.randn(*s, dtype=torch.bfloat16) * 1.6)(D, 3 * D)),
            "wo": _w((lambda *s: torch.randn(*s, dtype=torch.bfloat16) * 0.1)(D, D)),
        }
    _B_in = _B_setup()

    return {
        "A_x": _A_in["x"],
        "A_wqkv": _A_in["wqkv"],
        "A_wo": _A_in["wo"],
        "B_x": _B_in["x"],
        "B_wqkv": _B_in["wqkv"],
        "B_wo": _B_in["wo"],
        "gate_w": _w((lambda *s: torch.randn(*s, dtype=torch.bfloat16) * 0.05)(640) * 16.0),
    }

def reference(A_x, A_wqkv, A_wo, B_x, B_wqkv, B_wo, gate_w):
    def _A_ref(x, wqkv, wo):
        B, S, D = x.shape
        H = 32; Dh = D // H
        W, dil = 8, 2
        qkv = (lambda x, *d: x.permute(*d))((x @ wqkv).reshape(B, S, 3, H, Dh), 2, 0, 3, 1, 4)
        q, k, v = qkv[0], qkv[1], qkv[2]
        scale = Dh ** -0.5
        pos = torch.arange(S)
        off = torch.arange(W) * dil
        idx = pos[:, None] - off[None, :]
        mask = idx >= 0
        idx_c = torch.where(mask, idx, 0).reshape(-1)
        kg = k[:, :, idx_c, :].reshape(B, H, S, W, Dh)
        vg = v[:, :, idx_c, :].reshape(B, H, S, W, Dh)
        logits = torch.einsum("bhsd,bhswd->bhsw", q, kg) * scale
        logits = torch.where(mask[None, None, :, :], logits, -1e9)
        attn = _softmax(logits, axis=-1)
        o = torch.einsum("bhsw,bhswd->bhsd", attn, vg)
        return (lambda x, *d: x.permute(*d))(o, 0, 2, 1, 3).reshape(B, S, D) @ wo

    def _B_ref(x, wqkv, wo):
        B, S, D = x.shape
        H = 32; Dh = D // H
        qkv = (lambda x, *d: x.permute(*d))((x @ wqkv).reshape(B, S, 3, H, Dh), 2, 0, 3, 1, 4)
        q, k, v = qkv[0], qkv[1], qkv[2]
        scale = Dh ** -0.5
        scores = torch.einsum("bhqd,bhkd->bhqk", q, k) * scale
        p = _softmax(scores, axis=-1)
        o = torch.einsum("bhqk,bhkd->bhqd", p, v)
        return (lambda x, *d: x.permute(*d))(o, 0, 2, 1, 3).reshape(B, S, D) @ wo

    x = A_x
    g = _sigmoid((x * gate_w).sum(-1, keepdims=True))
    a = _A_ref(x, A_wqkv, A_wo)
    b = _B_ref(x, B_wqkv, B_wo)
    return g * a + (1 - g) * b
```

```asm
; @launch kernel=k1_qkv_kernel grid=(256,1,1) block=(512,1,1) lds=147456
; @launch kernel=k2_attn_kernel grid=(256,1,1) block=(512,1,1) lds=163840
.amdgcn_target "amdgcn-amd-amdhsa--gfx950"
.text
.globl k1_qkv_kernel
.p2align 8
.type k1_qkv_kernel,@function
k1_qkv_kernel:
    s_cmp_ge_u32 s2, 256
    s_cbranch_scc1 K1_END
    s_getpc_b64 s[78:79]
K1_PC0:
    s_sub_u32 s78, s78, K1_PC0-k1_qkv_kernel
    s_subb_u32 s79, s79, 0
    v_lshlrev_b32 v180, 7, v0
    v_cmp_gt_u32 vcc, (K1_TEXT_END-k1_qkv_kernel), v180
    s_and_saveexec_b64 s[72:73], vcc
    s_cbranch_execz K1_SPF
    global_load_dword v181, v180, s[78:79]
K1_SPF:
    s_mov_b64 exec, s[72:73]
    s_lshr_b32 s45, s2, 2
    s_and_b32 s45, s45, 1
    s_mul_i32 s46, s45, 24
    s_add_u32 s46, s46, 8
    s_load_dwordx2 s[10:11], s[0:1], s46
    s_load_dwordx2 s[8:9], s[0:1], 0
    s_load_dwordx2 s[4:5], s[0:1], 72
    s_load_dwordx2 s[6:7], s[0:1], 48
    v_and_b32 v1, 63, v0
    v_lshrrev_b32 v18, 6, v0
    s_lshr_b32 s46, s2, 3
    v_readfirstlane_b32 s32, v18
    s_and_b32 s43, s2, 3
    s_lshl_b32 s43, s43, 1
    s_and_b32 s47, s46, 1
    s_add_u32 s43, s43, s47
    s_lshr_b32 s44, s46, 1
    s_cmp_ge_u32 s44, 15
    s_cbranch_scc1 K1_GATE
    s_and_b32 s33, s32, 3
    s_lshr_b32 s34, s32, 2
    v_lshrrev_b32 v18, 3, v1
    v_lshrrev_b32 v19, 4, v1
    v_xor_b32 v19, v19, v1
    v_and_b32 v19, 7, v19
    s_lshl_b32 s46, s43, 8
    s_lshl_b32 s47, s32, 5
    s_add_u32 s46, s46, s47
    v_add_u32 v18, s46, v18
    v_mul_u32_u24 v18, 1280, v18
    v_lshl_add_u32 v2, v19, 4, v18
    v_xor_b32 v3, 64, v2
    v_lshrrev_b32 v18, 4, v1
    v_lshlrev_b32 v19, 2, v18
    v_xor_b32 v19, v19, v1
    v_and_b32 v19, 15, v19
    s_lshl_b32 s46, s32, 3
    v_add_u32 v18, s46, v18
    v_mul_u32_u24 v18, 3840, v18
    v_lshl_add_u32 v18, v19, 4, v18
    s_lshl_b32 s46, s44, 8
    v_add_u32 v4, s46, v18
    s_lshl_b32 s41, s32, 12
    s_lshl_b32 s42, s32, 11
    s_add_u32 s42, s42, 32768
    s_waitcnt lgkmcnt(0)
    s_mov_b32 s12, s8
    s_and_b32 s13, s9, 0xffff
    s_mov_b32 s14, 2621440
    s_mov_b32 s15, 0x00020000
    s_mov_b32 s16, s10
    s_and_b32 s17, s11, 0xffff
    s_mov_b32 s18, 2457600
    s_mov_b32 s19, 0x00020000
    s_mov_b32 s38, 0
    s_mov_b32 s39, 0
    s_mov_b32 s37, 0
    s_add_u32 m0, s37, s41
    s_add_u32 s48, s38, 0
    buffer_load_dwordx4 v2, s[12:15], s48 offen lds
    s_add_u32 m0, m0, 1024
    s_add_u32 s48, s38, 10240
    buffer_load_dwordx4 v3, s[12:15], s48 offen lds
    s_add_u32 m0, m0, 1024
    s_add_u32 s48, s38, 20480
    buffer_load_dwordx4 v2, s[12:15], s48 offen lds
    s_add_u32 m0, m0, 1024
    s_add_u32 s48, s38, 30720
    buffer_load_dwordx4 v3, s[12:15], s48 offen lds
    s_add_u32 m0, s37, s42
    s_add_u32 s48, s39, 0
    buffer_load_dwordx4 v4, s[16:19], s48 offen lds
    s_add_u32 m0, m0, 1024
    s_add_u32 s48, s39, 15360
    buffer_load_dwordx4 v4, s[16:19], s48 offen lds
    s_add_u32 s38, s38, 128
    s_add_u32 s39, s39, 245760
    s_mov_b32 s20, s4
    s_and_b32 s21, s5, 0xffff
    s_mov_b32 s22, 37748736
    s_mov_b32 s23, 0x00020000
    v_and_b32 v18, 31, v1
    v_lshrrev_b32 v19, 5, v1
    v_bfe_u32 v20, v1, 1, 3
    v_xor_b32 v20, v20, v19
    v_lshlrev_b32 v20, 4, v20
    v_lshl_add_u32 v6, v18, 7, v20
    s_lshl_b32 s46, s33, 13
    v_add_u32 v6, s46, v6
    v_xor_b32 v7, 32, v6
    v_xor_b32 v8, 64, v6
    v_xor_b32 v9, 96, v6
    v_bfe_u32 v20, v1, 2, 2
    v_lshl_add_u32 v21, v19, 3, v20
    v_lshlrev_b32 v21, 8, v21
    v_and_b32 v22, 3, v1
    v_lshl_add_u32 v21, v22, 3, v21
    v_bfe_u32 v22, v1, 4, 1
    v_lshl_add_u32 v21, v22, 5, v21
    v_add_u32 v21, 32768, v21
    s_lshl_b32 s46, s34, 1
    s_add_u32 s47, s46, 0
    v_xor_b32 v23, s47, v20
    v_lshl_add_u32 v10, v23, 6, v21
    s_add_u32 s47, s46, 1
    v_xor_b32 v23, s47, v20
    v_lshl_add_u32 v11, v23, 6, v21
    s_mul_i32 s50, s44, 52
    s_lshr_b32 s50, s50, 8
    s_mul_i32 s46, s50, 5
    s_sub_u32 s51, s44, s46
    s_lshl_b32 s51, s51, 7
    s_lshl_b32 s46, s34, 6
    s_add_u32 s51, s51, s46
    s_cmp_eq_u32 s50, 2
    s_cbranch_scc1 K1_VPREP
    s_cmp_eq_u32 s50, 0
    s_cselect_b32 s56, 0x3ea52b5c, 1.0
    s_mov_b32 s57, s56
    s_mov_b32 s46, 163840
    s_cselect_b32 s54, 81920, s46
    s_mov_b32 s46, 20480
    s_cselect_b32 s47, 10240, s46
    s_mul_i32 s52, s43, s47
    s_mul_i32 s47, s45, 2621440
    s_add_u32 s47, s47, 10485760
    s_mul_i32 s48, s45, 5242880
    s_cmp_eq_u32 s50, 0
    s_cselect_b32 s47, s47, s48
    s_add_u32 s52, s52, s47
    s_mul_i32 s46, s33, 2560
    s_add_u32 s52, s52, s46
    s_lshr_b32 s46, s51, 2
    v_lshrrev_b32 v24, 5, v1
    v_add_u32 v24, s46, v24
    v_and_b32 v25, 31, v1
    v_lshlrev_b32 v25, 3, v25
    v_mov_b32 v26, 0x43120
    v_add_u32 v18, 0, v24
    v_mul_u32_u24 v19, 52429, v18
    v_lshrrev_b32 v19, 18, v19
    v_mul_u32_u24 v20, 5, v19
    v_sub_u32 v20, v18, v20
    v_lshlrev_b32 v20, 2, v20
    v_bfe_u32 v20, v26, v20, 4
    v_lshl_add_u32 v20, v20, 8, v25
    v_mad_u32_u24 v160, v19, s54, v20
    v_add_u32 v18, 2, v24
    v_mul_u32_u24 v19, 52429, v18
    v_lshrrev_b32 v19, 18, v19
    v_mul_u32_u24 v20, 5, v19
    v_sub_u32 v20, v18, v20
    v_lshlrev_b32 v20, 2, v20
    v_bfe_u32 v20, v26, v20, 4
    v_lshl_add_u32 v20, v20, 8, v25
    v_mad_u32_u24 v161, v19, s54, v20
    v_add_u32 v18, 4, v24
    v_mul_u32_u24 v19, 52429, v18
    v_lshrrev_b32 v19, 18, v19
    v_mul_u32_u24 v20, 5, v19
    v_sub_u32 v20, v18, v20
    v_lshlrev_b32 v20, 2, v20
    v_bfe_u32 v20, v26, v20, 4
    v_lshl_add_u32 v20, v20, 8, v25
    v_mad_u32_u24 v162, v19, s54, v20
    v_add_u32 v18, 6, v24
    v_mul_u32_u24 v19, 52429, v18
    v_lshrrev_b32 v19, 18, v19
    v_mul_u32_u24 v20, 5, v19
    v_sub_u32 v20, v18, v20
    v_lshlrev_b32 v20, 2, v20
    v_bfe_u32 v20, v26, v20, 4
    v_lshl_add_u32 v20, v20, 8, v25
    v_mad_u32_u24 v163, v19, s54, v20
    v_add_u32 v18, 8, v24
    v_mul_u32_u24 v19, 52429, v18
    v_lshrrev_b32 v19, 18, v19
    v_mul_u32_u24 v20, 5, v19
    v_sub_u32 v20, v18, v20
    v_lshlrev_b32 v20, 2, v20
    v_bfe_u32 v20, v26, v20, 4
    v_lshl_add_u32 v20, v20, 8, v25
    v_mad_u32_u24 v164, v19, s54, v20
    v_add_u32 v18, 10, v24
    v_mul_u32_u24 v19, 52429, v18
    v_lshrrev_b32 v19, 18, v19
    v_mul_u32_u24 v20, 5, v19
    v_sub_u32 v20, v18, v20
    v_lshlrev_b32 v20, 2, v20
    v_bfe_u32 v20, v26, v20, 4
    v_lshl_add_u32 v20, v20, 8, v25
    v_mad_u32_u24 v165, v19, s54, v20
    v_add_u32 v18, 12, v24
    v_mul_u32_u24 v19, 52429, v18
    v_lshrrev_b32 v19, 18, v19
    v_mul_u32_u24 v20, 5, v19
    v_sub_u32 v20, v18, v20
    v_lshlrev_b32 v20, 2, v20
    v_bfe_u32 v20, v26, v20, 4
    v_lshl_add_u32 v20, v20, 8, v25
    v_mad_u32_u24 v166, v19, s54, v20
    v_add_u32 v18, 14, v24
    v_mul_u32_u24 v19, 52429, v18
    v_lshrrev_b32 v19, 18, v19
    v_mul_u32_u24 v20, 5, v19
    v_sub_u32 v20, v18, v20
    v_lshlrev_b32 v20, 2, v20
    v_bfe_u32 v20, v26, v20, 4
    v_lshl_add_u32 v20, v20, 8, v25
    v_mad_u32_u24 v167, v19, s54, v20
    v_and_b32 v18, 1, v1
    v_cmp_eq_u32 vcc, 0, v18
    v_lshlrev_b32 v18, 3, v18
    s_nop 0
    s_mov_b64 s[60:61], vcc
    v_cndmask_b32 v168, v161, v160, vcc
    v_sub_u32 v168, v168, v18
    v_cndmask_b32 v169, v163, v162, vcc
    v_sub_u32 v169, v169, v18
    v_cndmask_b32 v170, v165, v164, vcc
    v_sub_u32 v170, v170, v18
    v_cndmask_b32 v171, v167, v166, vcc
    v_sub_u32 v171, v171, v18
    s_branch K1_T
K1_VPREP:
    s_mul_i32 s52, s43, 20480
    s_mul_i32 s46, s45, 5242880
    s_add_u32 s52, s52, s46
    s_mul_i32 s46, s33, 2560
    s_add_u32 s52, s52, s46
    s_add_u32 s52, s52, 10240
    s_mov_b32 s54, 163840
    s_add_u32 s46, s51, 0
    v_and_b32 v18, 31, v1
    v_add_u32 v18, s46, v18
    v_mul_u32_u24 v19, 52429, v18
    v_lshrrev_b32 v19, 20, v19
    v_mul_u32_u24 v20, 20, v19
    v_sub_u32 v20, v18, v20
    v_lshrrev_b32 v21, 5, v1
    v_mul_u32_u24 v21, 320, v21
    v_lshl_add_u32 v21, v20, 4, v21
    v_mad_u32_u24 v160, v19, s54, v21
    s_add_u32 s46, s51, 32
    v_and_b32 v18, 31, v1
    v_add_u32 v18, s46, v18
    v_mul_u32_u24 v19, 52429, v18
    v_lshrrev_b32 v19, 20, v19
    v_mul_u32_u24 v20, 20, v19
    v_sub_u32 v20, v18, v20
    v_lshrrev_b32 v21, 5, v1
    v_mul_u32_u24 v21, 320, v21
    v_lshl_add_u32 v21, v20, 4, v21
    v_mad_u32_u24 v161, v19, s54, v21
    s_branch K1_C
K1_T:
    s_mov_b32 s37, 49152
    s_add_u32 m0, s37, s41
    s_add_u32 s48, s38, 0
    buffer_load_dwordx4 v2, s[12:15], s48 offen lds
    s_add_u32 m0, m0, 1024
    s_add_u32 s48, s38, 10240
    buffer_load_dwordx4 v3, s[12:15], s48 offen lds
    s_add_u32 m0, m0, 1024
    s_add_u32 s48, s38, 20480
    buffer_load_dwordx4 v2, s[12:15], s48 offen lds
    s_add_u32 m0, m0, 1024
    s_add_u32 s48, s38, 30720
    buffer_load_dwordx4 v3, s[12:15], s48 offen lds
    s_add_u32 m0, s37, s42
    s_add_u32 s48, s39, 0
    buffer_load_dwordx4 v4, s[16:19], s48 offen lds
    s_add_u32 m0, m0, 1024
    s_add_u32 s48, s39, 15360
    buffer_load_dwordx4 v4, s[16:19], s48 offen lds
    s_add_u32 s38, s38, 128
    s_add_u32 s39, s39, 245760
    s_mov_b32 s37, 98304
    s_waitcnt vmcnt(6)
    s_barrier
    s_mov_b32 s36, 0
    v_add_u32 v12, s36, v6
    v_add_u32 v13, s36, v7
    v_add_u32 v14, s36, v8
    v_add_u32 v15, s36, v9
    v_add_u32 v16, s36, v10
    v_add_u32 v17, s36, v11
    ds_read_b128 v[32:35], v12 offset:0
    ds_read_b64_tr_b16 v[64:65], v16 offset:0
    ds_read_b64_tr_b16 v[66:67], v16 offset:1024
    ds_read_b128 v[36:39], v12 offset:4096
    ds_read_b64_tr_b16 v[68:69], v17 offset:0
    ds_read_b64_tr_b16 v[70:71], v17 offset:1024
    ds_read_b128 v[40:43], v13 offset:0
    ds_read_b64_tr_b16 v[72:73], v16 offset:4096
    ds_read_b64_tr_b16 v[74:75], v16 offset:5120
    ds_read_b128 v[44:47], v13 offset:4096
    ds_read_b64_tr_b16 v[76:77], v17 offset:4096
    ds_read_b64_tr_b16 v[78:79], v17 offset:5120
    s_mov_b32 s35, 0
    s_waitcnt lgkmcnt(0)
    v_mfma_f32_32x32x16_bf16 v[96:111], v[64:67], v[32:35], 0
    ds_read_b128 v[48:51], v14 offset:0
    ds_read_b64_tr_b16 v[80:81], v16 offset:8192
    s_add_u32 m0, s37, s41
    s_add_u32 s48, s38, 0
    buffer_load_dwordx4 v2, s[12:15], s48 offen lds
    ds_read_b64_tr_b16 v[82:83], v16 offset:9216
    v_mfma_f32_32x32x16_bf16 v[112:127], v[64:67], v[36:39], 0
    ds_read_b128 v[52:55], v14 offset:4096
    s_add_u32 m0, m0, 1024
    s_add_u32 s48, s38, 10240
    buffer_load_dwordx4 v3, s[12:15], s48 offen lds
    ds_read_b64_tr_b16 v[84:85], v17 offset:8192
    v_mfma_f32_32x32x16_bf16 v[128:143], v[68:71], v[32:35], 0
    ds_read_b64_tr_b16 v[86:87], v17 offset:9216
    s_add_u32 m0, m0, 1024
    s_add_u32 s48, s38, 20480
    buffer_load_dwordx4 v2, s[12:15], s48 offen lds
    ds_read_b128 v[56:59], v15 offset:0
    v_mfma_f32_32x32x16_bf16 v[144:159], v[68:71], v[36:39], 0
    ds_read_b64_tr_b16 v[88:89], v16 offset:12288
    s_add_u32 m0, m0, 1024
    s_add_u32 s48, s38, 30720
    buffer_load_dwordx4 v3, s[12:15], s48 offen lds
    ds_read_b64_tr_b16 v[90:91], v16 offset:13312
    v_mfma_f32_32x32x16_bf16 v[96:111], v[72:75], v[40:43], v[96:111]
    ds_read_b128 v[60:63], v15 offset:4096
    s_add_u32 m0, s37, s42
    s_add_u32 s48, s39, 0
    buffer_load_dwordx4 v4, s[16:19], s48 offen lds
    ds_read_b64_tr_b16 v[92:93], v17 offset:12288
    v_mfma_f32_32x32x16_bf16 v[112:127], v[72:75], v[44:47], v[112:127]
    ds_read_b64_tr_b16 v[94:95], v17 offset:13312
    s_add_u32 m0, m0, 1024
    s_add_u32 s48, s39, 15360
    buffer_load_dwordx4 v4, s[16:19], s48 offen lds
    s_add_u32 s38, s38, 128
    s_add_u32 s39, s39, 245760
    s_add_u32 s36, s36, 49152
    s_cmp_eq_u32 s36, 147456
    s_cselect_b32 s36, 0, s36
    v_mfma_f32_32x32x16_bf16 v[128:143], v[76:79], v[40:43], v[128:143]
    v_mfma_f32_32x32x16_bf16 v[144:159], v[76:79], v[44:47], v[144:159]
    s_waitcnt vmcnt(6) lgkmcnt(0)
    s_branch K1_T_WB
K1_T_LOOP:
    s_waitcnt lgkmcnt(0)
    s_cmp_ge_u32 s35, 8
    s_cbranch_scc1 K1_T_AND
    v_mfma_f32_32x32x16_bf16 v[96:111], v[64:67], v[32:35], v[96:111]
    ds_read_b128 v[48:51], v14 offset:0
    ds_read_b64_tr_b16 v[80:81], v16 offset:8192
    ds_read_b64_tr_b16 v[82:83], v16 offset:9216
    v_mfma_f32_32x32x16_bf16 v[112:127], v[64:67], v[36:39], v[112:127]
    ds_read_b128 v[52:55], v14 offset:4096
    s_add_u32 m0, m0, 1024
    s_add_u32 s48, s38, 30720
    buffer_load_dwordx4 v3, s[12:15], s48 offen lds
    ds_read_b64_tr_b16 v[84:85], v17 offset:8192
    v_mfma_f32_32x32x16_bf16 v[128:143], v[68:71], v[32:35], v[128:143]
    ds_read_b64_tr_b16 v[86:87], v17 offset:9216
    ds_read_b128 v[56:59], v15 offset:0
    v_mfma_f32_32x32x16_bf16 v[144:159], v[68:71], v[36:39], v[144:159]
    ds_read_b64_tr_b16 v[88:89], v16 offset:12288
    s_add_u32 m0, s37, s42
    s_add_u32 s48, s39, 0
    buffer_load_dwordx4 v4, s[16:19], s48 offen lds
    ds_read_b64_tr_b16 v[90:91], v16 offset:13312
    v_mfma_f32_32x32x16_bf16 v[96:111], v[72:75], v[40:43], v[96:111]
    ds_read_b128 v[60:63], v15 offset:4096
    ds_read_b64_tr_b16 v[92:93], v17 offset:12288
    ds_read_b64_tr_b16 v[94:95], v17 offset:13312
    v_mfma_f32_32x32x16_bf16 v[112:127], v[72:75], v[44:47], v[112:127]
    s_add_u32 m0, m0, 1024
    s_add_u32 s48, s39, 15360
    buffer_load_dwordx4 v4, s[16:19], s48 offen lds
    s_add_u32 s38, s38, 128
    s_add_u32 s39, s39, 245760
    s_add_u32 s36, s36, 49152
    s_cmp_eq_u32 s36, 147456
    s_cselect_b32 s36, 0, s36
    v_mfma_f32_32x32x16_bf16 v[128:143], v[76:79], v[40:43], v[128:143]
    v_mfma_f32_32x32x16_bf16 v[144:159], v[76:79], v[44:47], v[144:159]
K1_T_B:
    s_waitcnt vmcnt(6) lgkmcnt(0)
K1_T_WB:
    s_barrier
    v_mfma_f32_32x32x16_bf16 v[96:111], v[80:83], v[48:51], v[96:111]
    v_add_u32 v12, s36, v6
    v_add_u32 v13, s36, v7
    v_add_u32 v14, s36, v8
    v_add_u32 v15, s36, v9
    v_add_u32 v16, s36, v10
    v_add_u32 v17, s36, v11
    s_add_u32 s37, s37, 49152
    s_cmp_eq_u32 s37, 147456
    s_cselect_b32 s37, 0, s37
    s_cmp_ge_u32 s35, 7
    s_cbranch_scc1 K1_T_ND
    v_mfma_f32_32x32x16_bf16 v[112:127], v[80:83], v[52:55], v[112:127]
    ds_read_b128 v[32:35], v12 offset:0
    ds_read_b64_tr_b16 v[64:65], v16 offset:0
    ds_read_b64_tr_b16 v[66:67], v16 offset:1024
    v_mfma_f32_32x32x16_bf16 v[128:143], v[84:87], v[48:51], v[128:143]
    ds_read_b128 v[36:39], v12 offset:4096
    s_add_u32 m0, s37, s41
    s_add_u32 s48, s38, 0
    buffer_load_dwordx4 v2, s[12:15], s48 offen lds
    ds_read_b64_tr_b16 v[68:69], v17 offset:0
    v_mfma_f32_32x32x16_bf16 v[144:159], v[84:87], v[52:55], v[144:159]
    ds_read_b64_tr_b16 v[70:71], v17 offset:1024
    ds_read_b128 v[40:43], v13 offset:0
    v_mfma_f32_32x32x16_bf16 v[96:111], v[88:91], v[56:59], v[96:111]
    ds_read_b64_tr_b16 v[72:73], v16 offset:4096
    s_add_u32 m0, m0, 1024
    s_add_u32 s48, s38, 10240
    buffer_load_dwordx4 v3, s[12:15], s48 offen lds
    ds_read_b64_tr_b16 v[74:75], v16 offset:5120
    v_mfma_f32_32x32x16_bf16 v[112:127], v[88:91], v[60:63], v[112:127]
    ds_read_b128 v[44:47], v13 offset:4096
    ds_read_b64_tr_b16 v[76:77], v17 offset:4096
    ds_read_b64_tr_b16 v[78:79], v17 offset:5120
    v_mfma_f32_32x32x16_bf16 v[128:143], v[92:95], v[56:59], v[128:143]
    s_add_u32 m0, m0, 1024
    s_add_u32 s48, s38, 20480
    buffer_load_dwordx4 v2, s[12:15], s48 offen lds
    s_add_u32 s35, s35, 1
    v_mfma_f32_32x32x16_bf16 v[144:159], v[92:95], v[60:63], v[144:159]
    s_branch K1_T_LOOP
K1_T_ND:
    v_mfma_f32_32x32x16_bf16 v[112:127], v[80:83], v[52:55], v[112:127]
    ds_read_b128 v[32:35], v12 offset:0
    ds_read_b64_tr_b16 v[64:65], v16 offset:0
    ds_read_b64_tr_b16 v[66:67], v16 offset:1024
    v_mfma_f32_32x32x16_bf16 v[128:143], v[84:87], v[48:51], v[128:143]
    ds_read_b128 v[36:39], v12 offset:4096
    ds_read_b64_tr_b16 v[68:69], v17 offset:0
    v_mfma_f32_32x32x16_bf16 v[144:159], v[84:87], v[52:55], v[144:159]
    ds_read_b64_tr_b16 v[70:71], v17 offset:1024
    ds_read_b128 v[40:43], v13 offset:0
    v_mfma_f32_32x32x16_bf16 v[96:111], v[88:91], v[56:59], v[96:111]
    ds_read_b64_tr_b16 v[72:73], v16 offset:4096
    ds_read_b64_tr_b16 v[74:75], v16 offset:5120
    v_mfma_f32_32x32x16_bf16 v[112:127], v[88:91], v[60:63], v[112:127]
    ds_read_b128 v[44:47], v13 offset:4096
    ds_read_b64_tr_b16 v[76:77], v17 offset:4096
    v_mfma_f32_32x32x16_bf16 v[128:143], v[92:95], v[56:59], v[128:143]
    ds_read_b64_tr_b16 v[78:79], v17 offset:5120
    s_add_u32 s35, s35, 1
    v_mfma_f32_32x32x16_bf16 v[144:159], v[92:95], v[60:63], v[144:159]
    s_cmp_lt_u32 s35, 10
    s_cbranch_scc1 K1_T_LOOP
    s_nop 7
    s_nop 3
    v_pk_mul_f32 v[96:97], v[96:97], s[56:57]
    v_pk_mul_f32 v[98:99], v[98:99], s[56:57]
    v_cvt_pk_bf16_f32 v32, v96, v97
    v_cvt_pk_bf16_f32 v33, v98, v99
    v_pk_mul_f32 v[100:101], v[100:101], s[56:57]
    v_pk_mul_f32 v[102:103], v[102:103], s[56:57]
    v_cvt_pk_bf16_f32 v34, v100, v101
    v_cvt_pk_bf16_f32 v35, v102, v103
    v_pk_mul_f32 v[104:105], v[104:105], s[56:57]
    v_pk_mul_f32 v[106:107], v[106:107], s[56:57]
    v_cvt_pk_bf16_f32 v36, v104, v105
    v_cvt_pk_bf16_f32 v37, v106, v107
    v_pk_mul_f32 v[108:109], v[108:109], s[56:57]
    v_pk_mul_f32 v[110:111], v[110:111], s[56:57]
    v_cvt_pk_bf16_f32 v38, v108, v109
    v_cvt_pk_bf16_f32 v39, v110, v111
    s_mov_b64 vcc, s[60:61]
    v_cndmask_b32_dpp v40, v34, v32, vcc quad_perm:[1,0,3,2] row_mask:0xf bank_mask:0xf
    v_cndmask_b32_dpp v41, v35, v33, vcc quad_perm:[1,0,3,2] row_mask:0xf bank_mask:0xf
    v_cndmask_b32_dpp v44, v38, v36, vcc quad_perm:[1,0,3,2] row_mask:0xf bank_mask:0xf
    v_cndmask_b32_dpp v45, v39, v37, vcc quad_perm:[1,0,3,2] row_mask:0xf bank_mask:0xf
    s_not_b64 vcc, vcc
    v_cndmask_b32_dpp v42, v32, v34, vcc quad_perm:[1,0,3,2] row_mask:0xf bank_mask:0xf
    v_cndmask_b32_dpp v43, v33, v35, vcc quad_perm:[1,0,3,2] row_mask:0xf bank_mask:0xf
    v_cndmask_b32_dpp v46, v36, v38, vcc quad_perm:[1,0,3,2] row_mask:0xf bank_mask:0xf
    v_cndmask_b32_dpp v47, v37, v39, vcc quad_perm:[1,0,3,2] row_mask:0xf bank_mask:0xf
    buffer_store_dwordx4 v[40:43], v168, s[20:23], s52 offen offset:0 sc1
    buffer_store_dwordx4 v[44:47], v169, s[20:23], s52 offen offset:0 sc1
    v_pk_mul_f32 v[112:113], v[112:113], s[56:57]
    v_pk_mul_f32 v[114:115], v[114:115], s[56:57]
    v_cvt_pk_bf16_f32 v48, v112, v113
    v_cvt_pk_bf16_f32 v49, v114, v115
    v_pk_mul_f32 v[116:117], v[116:117], s[56:57]
    v_pk_mul_f32 v[118:119], v[118:119], s[56:57]
    v_cvt_pk_bf16_f32 v50, v116, v117
    v_cvt_pk_bf16_f32 v51, v118, v119
    v_pk_mul_f32 v[120:121], v[120:121], s[56:57]
    v_pk_mul_f32 v[122:123], v[122:123], s[56:57]
    v_cvt_pk_bf16_f32 v52, v120, v121
    v_cvt_pk_bf16_f32 v53, v122, v123
    v_pk_mul_f32 v[124:125], v[124:125], s[56:57]
    v_pk_mul_f32 v[126:127], v[126:127], s[56:57]
    v_cvt_pk_bf16_f32 v54, v124, v125
    v_cvt_pk_bf16_f32 v55, v126, v127
    s_mov_b64 vcc, s[60:61]
    v_cndmask_b32_dpp v56, v50, v48, vcc quad_perm:[1,0,3,2] row_mask:0xf bank_mask:0xf
    v_cndmask_b32_dpp v57, v51, v49, vcc quad_perm:[1,0,3,2] row_mask:0xf bank_mask:0xf
    v_cndmask_b32_dpp v60, v54, v52, vcc quad_perm:[1,0,3,2] row_mask:0xf bank_mask:0xf
    v_cndmask_b32_dpp v61, v55, v53, vcc quad_perm:[1,0,3,2] row_mask:0xf bank_mask:0xf
    s_not_b64 vcc, vcc
    v_cndmask_b32_dpp v58, v48, v50, vcc quad_perm:[1,0,3,2] row_mask:0xf bank_mask:0xf
    v_cndmask_b32_dpp v59, v49, v51, vcc quad_perm:[1,0,3,2] row_mask:0xf bank_mask:0xf
    v_cndmask_b32_dpp v62, v52, v54, vcc quad_perm:[1,0,3,2] row_mask:0xf bank_mask:0xf
    v_cndmask_b32_dpp v63, v53, v55, vcc quad_perm:[1,0,3,2] row_mask:0xf bank_mask:0xf
    buffer_store_dwordx4 v[56:59], v168, s[20:23], s52 offen offset:1280 sc1
    buffer_store_dwordx4 v[60:63], v169, s[20:23], s52 offen offset:1280 sc1
    v_pk_mul_f32 v[128:129], v[128:129], s[56:57]
    v_pk_mul_f32 v[130:131], v[130:131], s[56:57]
    v_cvt_pk_bf16_f32 v64, v128, v129
    v_cvt_pk_bf16_f32 v65, v130, v131
    v_pk_mul_f32 v[132:133], v[132:133], s[56:57]
    v_pk_mul_f32 v[134:135], v[134:135], s[56:57]
    v_cvt_pk_bf16_f32 v66, v132, v133
    v_cvt_pk_bf16_f32 v67, v134, v135
    v_pk_mul_f32 v[136:137], v[136:137], s[56:57]
    v_pk_mul_f32 v[138:139], v[138:139], s[56:57]
    v_cvt_pk_bf16_f32 v68, v136, v137
    v_cvt_pk_bf16_f32 v69, v138, v139
    v_pk_mul_f32 v[140:141], v[140:141], s[56:57]
    v_pk_mul_f32 v[142:143], v[142:143], s[56:57]
    v_cvt_pk_bf16_f32 v70, v140, v141
    v_cvt_pk_bf16_f32 v71, v142, v143
    s_mov_b64 vcc, s[60:61]
    v_cndmask_b32_dpp v72, v66, v64, vcc quad_perm:[1,0,3,2] row_mask:0xf bank_mask:0xf
    v_cndmask_b32_dpp v73, v67, v65, vcc quad_perm:[1,0,3,2] row_mask:0xf bank_mask:0xf
    v_cndmask_b32_dpp v76, v70, v68, vcc quad_perm:[1,0,3,2] row_mask:0xf bank_mask:0xf
    v_cndmask_b32_dpp v77, v71, v69, vcc quad_perm:[1,0,3,2] row_mask:0xf bank_mask:0xf
    s_not_b64 vcc, vcc
    v_cndmask_b32_dpp v74, v64, v66, vcc quad_perm:[1,0,3,2] row_mask:0xf bank_mask:0xf
    v_cndmask_b32_dpp v75, v65, v67, vcc quad_perm:[1,0,3,2] row_mask:0xf bank_mask:0xf
    v_cndmask_b32_dpp v78, v68, v70, vcc quad_perm:[1,0,3,2] row_mask:0xf bank_mask:0xf
    v_cndmask_b32_dpp v79, v69, v71, vcc quad_perm:[1,0,3,2] row_mask:0xf bank_mask:0xf
    buffer_store_dwordx4 v[72:75], v170, s[20:23], s52 offen offset:0 sc1
    buffer_store_dwordx4 v[76:79], v171, s[20:23], s52 offen offset:0 sc1
    v_pk_mul_f32 v[144:145], v[144:145], s[56:57]
    v_pk_mul_f32 v[146:147], v[146:147], s[56:57]
    v_cvt_pk_bf16_f32 v80, v144, v145
    v_cvt_pk_bf16_f32 v81, v146, v147
    v_pk_mul_f32 v[148:149], v[148:149], s[56:57]
    v_pk_mul_f32 v[150:151], v[150:151], s[56:57]
    v_cvt_pk_bf16_f32 v82, v148, v149
    v_cvt_pk_bf16_f32 v83, v150, v151
    v_pk_mul_f32 v[152:153], v[152:153], s[56:57]
    v_pk_mul_f32 v[154:155], v[154:155], s[56:57]
    v_cvt_pk_bf16_f32 v84, v152, v153
    v_cvt_pk_bf16_f32 v85, v154, v155
    v_pk_mul_f32 v[156:157], v[156:157], s[56:57]
    v_pk_mul_f32 v[158:159], v[158:159], s[56:57]
    v_cvt_pk_bf16_f32 v86, v156, v157
    v_cvt_pk_bf16_f32 v87, v158, v159
    s_mov_b64 vcc, s[60:61]
    v_cndmask_b32_dpp v88, v82, v80, vcc quad_perm:[1,0,3,2] row_mask:0xf bank_mask:0xf
    v_cndmask_b32_dpp v89, v83, v81, vcc quad_perm:[1,0,3,2] row_mask:0xf bank_mask:0xf
    v_cndmask_b32_dpp v92, v86, v84, vcc quad_perm:[1,0,3,2] row_mask:0xf bank_mask:0xf
    v_cndmask_b32_dpp v93, v87, v85, vcc quad_perm:[1,0,3,2] row_mask:0xf bank_mask:0xf
    s_not_b64 vcc, vcc
    v_cndmask_b32_dpp v90, v80, v82, vcc quad_perm:[1,0,3,2] row_mask:0xf bank_mask:0xf
    v_cndmask_b32_dpp v91, v81, v83, vcc quad_perm:[1,0,3,2] row_mask:0xf bank_mask:0xf
    v_cndmask_b32_dpp v94, v84, v86, vcc quad_perm:[1,0,3,2] row_mask:0xf bank_mask:0xf
    v_cndmask_b32_dpp v95, v85, v87, vcc quad_perm:[1,0,3,2] row_mask:0xf bank_mask:0xf
    buffer_store_dwordx4 v[88:91], v170, s[20:23], s52 offen offset:1280 sc1
    buffer_store_dwordx4 v[92:95], v171, s[20:23], s52 offen offset:1280 sc1
    s_branch K1_FIN
K1_T_AND:
    v_mfma_f32_32x32x16_bf16 v[96:111], v[64:67], v[32:35], v[96:111]
    ds_read_b128 v[48:51], v14 offset:0
    ds_read_b64_tr_b16 v[80:81], v16 offset:8192
    ds_read_b64_tr_b16 v[82:83], v16 offset:9216
    v_mfma_f32_32x32x16_bf16 v[112:127], v[64:67], v[36:39], v[112:127]
    ds_read_b128 v[52:55], v14 offset:4096
    ds_read_b64_tr_b16 v[84:85], v17 offset:8192
    v_mfma_f32_32x32x16_bf16 v[128:143], v[68:71], v[32:35], v[128:143]
    ds_read_b64_tr_b16 v[86:87], v17 offset:9216
    ds_read_b128 v[56:59], v15 offset:0
    v_mfma_f32_32x32x16_bf16 v[144:159], v[68:71], v[36:39], v[144:159]
    ds_read_b64_tr_b16 v[88:89], v16 offset:12288
    ds_read_b64_tr_b16 v[90:91], v16 offset:13312
    v_mfma_f32_32x32x16_bf16 v[96:111], v[72:75], v[40:43], v[96:111]
    ds_read_b128 v[60:63], v15 offset:4096
    ds_read_b64_tr_b16 v[92:93], v17 offset:12288
    v_mfma_f32_32x32x16_bf16 v[112:127], v[72:75], v[44:47], v[112:127]
    ds_read_b64_tr_b16 v[94:95], v17 offset:13312
    s_add_u32 s36, s36, 49152
    s_cmp_eq_u32 s36, 147456
    s_cselect_b32 s36, 0, s36
    v_mfma_f32_32x32x16_bf16 v[128:143], v[76:79], v[40:43], v[128:143]
    v_mfma_f32_32x32x16_bf16 v[144:159], v[76:79], v[44:47], v[144:159]
    s_waitcnt vmcnt(0) lgkmcnt(0)
    s_branch K1_T_WB
K1_C:
    s_mov_b32 s37, 49152
    s_add_u32 m0, s37, s41
    s_add_u32 s48, s38, 0
    buffer_load_dwordx4 v2, s[12:15], s48 offen lds
    s_add_u32 m0, m0, 1024
    s_add_u32 s48, s38, 10240
    buffer_load_dwordx4 v3, s[12:15], s48 offen lds
    s_add_u32 m0, m0, 1024
    s_add_u32 s48, s38, 20480
    buffer_load_dwordx4 v2, s[12:15], s48 offen lds
    s_add_u32 m0, m0, 1024
    s_add_u32 s48, s38, 30720
    buffer_load_dwordx4 v3, s[12:15], s48 offen lds
    s_add_u32 m0, s37, s42
    s_add_u32 s48, s39, 0
    buffer_load_dwordx4 v4, s[16:19], s48 offen lds
    s_add_u32 m0, m0, 1024
    s_add_u32 s48, s39, 15360
    buffer_load_dwordx4 v4, s[16:19], s48 offen lds
    s_add_u32 s38, s38, 128
    s_add_u32 s39, s39, 245760
    s_mov_b32 s37, 98304
    s_waitcnt vmcnt(6)
    s_barrier
    s_mov_b32 s36, 0
    v_add_u32 v12, s36, v6
    v_add_u32 v13, s36, v7
    v_add_u32 v14, s36, v8
    v_add_u32 v15, s36, v9
    v_add_u32 v16, s36, v10
    v_add_u32 v17, s36, v11
    ds_read_b128 v[32:35], v12 offset:0
    ds_read_b64_tr_b16 v[64:65], v16 offset:0
    ds_read_b64_tr_b16 v[66:67], v16 offset:1024
    ds_read_b128 v[36:39], v12 offset:4096
    ds_read_b64_tr_b16 v[68:69], v17 offset:0
    ds_read_b64_tr_b16 v[70:71], v17 offset:1024
    ds_read_b128 v[40:43], v13 offset:0
    ds_read_b64_tr_b16 v[72:73], v16 offset:4096
    ds_read_b64_tr_b16 v[74:75], v16 offset:5120
    ds_read_b128 v[44:47], v13 offset:4096
    ds_read_b64_tr_b16 v[76:77], v17 offset:4096
    ds_read_b64_tr_b16 v[78:79], v17 offset:5120
    s_mov_b32 s35, 0
    s_waitcnt lgkmcnt(0)
    v_mfma_f32_32x32x16_bf16 v[96:111], v[32:35], v[64:67], 0
    ds_read_b128 v[48:51], v14 offset:0
    ds_read_b64_tr_b16 v[80:81], v16 offset:8192
    s_add_u32 m0, s37, s41
    s_add_u32 s48, s38, 0
    buffer_load_dwordx4 v2, s[12:15], s48 offen lds
    ds_read_b64_tr_b16 v[82:83], v16 offset:9216
    v_mfma_f32_32x32x16_bf16 v[112:127], v[36:39], v[64:67], 0
    ds_read_b128 v[52:55], v14 offset:4096
    s_add_u32 m0, m0, 1024
    s_add_u32 s48, s38, 10240
    buffer_load_dwordx4 v3, s[12:15], s48 offen lds
    ds_read_b64_tr_b16 v[84:85], v17 offset:8192
    v_mfma_f32_32x32x16_bf16 v[128:143], v[32:35], v[68:71], 0
    ds_read_b64_tr_b16 v[86:87], v17 offset:9216
    s_add_u32 m0, m0, 1024
    s_add_u32 s48, s38, 20480
    buffer_load_dwordx4 v2, s[12:15], s48 offen lds
    ds_read_b128 v[56:59], v15 offset:0
    v_mfma_f32_32x32x16_bf16 v[144:159], v[36:39], v[68:71], 0
    ds_read_b64_tr_b16 v[88:89], v16 offset:12288
    s_add_u32 m0, m0, 1024
    s_add_u32 s48, s38, 30720
    buffer_load_dwordx4 v3, s[12:15], s48 offen lds
    ds_read_b64_tr_b16 v[90:91], v16 offset:13312
    v_mfma_f32_32x32x16_bf16 v[96:111], v[40:43], v[72:75], v[96:111]
    ds_read_b128 v[60:63], v15 offset:4096
    s_add_u32 m0, s37, s42
    s_add_u32 s48, s39, 0
    buffer_load_dwordx4 v4, s[16:19], s48 offen lds
    ds_read_b64_tr_b16 v[92:93], v17 offset:12288
    v_mfma_f32_32x32x16_bf16 v[112:127], v[44:47], v[72:75], v[112:127]
    ds_read_b64_tr_b16 v[94:95], v17 offset:13312
    s_add_u32 m0, m0, 1024
    s_add_u32 s48, s39, 15360
    buffer_load_dwordx4 v4, s[16:19], s48 offen lds
    s_add_u32 s38, s38, 128
    s_add_u32 s39, s39, 245760
    s_add_u32 s36, s36, 49152
    s_cmp_eq_u32 s36, 147456
    s_cselect_b32 s36, 0, s36
    v_mfma_f32_32x32x16_bf16 v[128:143], v[40:43], v[76:79], v[128:143]
    v_mfma_f32_32x32x16_bf16 v[144:159], v[44:47], v[76:79], v[144:159]
    s_waitcnt vmcnt(6) lgkmcnt(0)
    s_branch K1_C_WB
K1_C_LOOP:
    s_waitcnt lgkmcnt(0)
    s_cmp_ge_u32 s35, 8
    s_cbranch_scc1 K1_C_AND
    v_mfma_f32_32x32x16_bf16 v[96:111], v[32:35], v[64:67], v[96:111]
    ds_read_b128 v[48:51], v14 offset:0
    ds_read_b64_tr_b16 v[80:81], v16 offset:8192
    ds_read_b64_tr_b16 v[82:83], v16 offset:9216
    v_mfma_f32_32x32x16_bf16 v[112:127], v[36:39], v[64:67], v[112:127]
    ds_read_b128 v[52:55], v14 offset:4096
    s_add_u32 m0, m0, 1024
    s_add_u32 s48, s38, 30720
    buffer_load_dwordx4 v3, s[12:15], s48 offen lds
    ds_read_b64_tr_b16 v[84:85], v17 offset:8192
    v_mfma_f32_32x32x16_bf16 v[128:143], v[32:35], v[68:71], v[128:143]
    ds_read_b64_tr_b16 v[86:87], v17 offset:9216
    ds_read_b128 v[56:59], v15 offset:0
    v_mfma_f32_32x32x16_bf16 v[144:159], v[36:39], v[68:71], v[144:159]
    ds_read_b64_tr_b16 v[88:89], v16 offset:12288
    s_add_u32 m0, s37, s42
    s_add_u32 s48, s39, 0
    buffer_load_dwordx4 v4, s[16:19], s48 offen lds
    ds_read_b64_tr_b16 v[90:91], v16 offset:13312
    v_mfma_f32_32x32x16_bf16 v[96:111], v[40:43], v[72:75], v[96:111]
    ds_read_b128 v[60:63], v15 offset:4096
    ds_read_b64_tr_b16 v[92:93], v17 offset:12288
    ds_read_b64_tr_b16 v[94:95], v17 offset:13312
    v_mfma_f32_32x32x16_bf16 v[112:127], v[44:47], v[72:75], v[112:127]
    s_add_u32 m0, m0, 1024
    s_add_u32 s48, s39, 15360
    buffer_load_dwordx4 v4, s[16:19], s48 offen lds
    s_add_u32 s38, s38, 128
    s_add_u32 s39, s39, 245760
    s_add_u32 s36, s36, 49152
    s_cmp_eq_u32 s36, 147456
    s_cselect_b32 s36, 0, s36
    v_mfma_f32_32x32x16_bf16 v[128:143], v[40:43], v[76:79], v[128:143]
    v_mfma_f32_32x32x16_bf16 v[144:159], v[44:47], v[76:79], v[144:159]
K1_C_B:
    s_waitcnt vmcnt(6) lgkmcnt(0)
K1_C_WB:
    s_barrier
    v_mfma_f32_32x32x16_bf16 v[96:111], v[48:51], v[80:83], v[96:111]
    v_add_u32 v12, s36, v6
    v_add_u32 v13, s36, v7
    v_add_u32 v14, s36, v8
    v_add_u32 v15, s36, v9
    v_add_u32 v16, s36, v10
    v_add_u32 v17, s36, v11
    s_add_u32 s37, s37, 49152
    s_cmp_eq_u32 s37, 147456
    s_cselect_b32 s37, 0, s37
    s_cmp_ge_u32 s35, 7
    s_cbranch_scc1 K1_C_ND
    v_mfma_f32_32x32x16_bf16 v[112:127], v[52:55], v[80:83], v[112:127]
    ds_read_b128 v[32:35], v12 offset:0
    ds_read_b64_tr_b16 v[64:65], v16 offset:0
    ds_read_b64_tr_b16 v[66:67], v16 offset:1024
    v_mfma_f32_32x32x16_bf16 v[128:143], v[48:51], v[84:87], v[128:143]
    ds_read_b128 v[36:39], v12 offset:4096
    s_add_u32 m0, s37, s41
    s_add_u32 s48, s38, 0
    buffer_load_dwordx4 v2, s[12:15], s48 offen lds
    ds_read_b64_tr_b16 v[68:69], v17 offset:0
    v_mfma_f32_32x32x16_bf16 v[144:159], v[52:55], v[84:87], v[144:159]
    ds_read_b64_tr_b16 v[70:71], v17 offset:1024
    ds_read_b128 v[40:43], v13 offset:0
    v_mfma_f32_32x32x16_bf16 v[96:111], v[56:59], v[88:91], v[96:111]
    ds_read_b64_tr_b16 v[72:73], v16 offset:4096
    s_add_u32 m0, m0, 1024
    s_add_u32 s48, s38, 10240
    buffer_load_dwordx4 v3, s[12:15], s48 offen lds
    ds_read_b64_tr_b16 v[74:75], v16 offset:5120
    v_mfma_f32_32x32x16_bf16 v[112:127], v[60:63], v[88:91], v[112:127]
    ds_read_b128 v[44:47], v13 offset:4096
    ds_read_b64_tr_b16 v[76:77], v17 offset:4096
    ds_read_b64_tr_b16 v[78:79], v17 offset:5120
    v_mfma_f32_32x32x16_bf16 v[128:143], v[56:59], v[92:95], v[128:143]
    s_add_u32 m0, m0, 1024
    s_add_u32 s48, s38, 20480
    buffer_load_dwordx4 v2, s[12:15], s48 offen lds
    s_add_u32 s35, s35, 1
    v_mfma_f32_32x32x16_bf16 v[144:159], v[60:63], v[92:95], v[144:159]
    s_branch K1_C_LOOP
K1_C_ND:
    v_mfma_f32_32x32x16_bf16 v[112:127], v[52:55], v[80:83], v[112:127]
    ds_read_b128 v[32:35], v12 offset:0
    ds_read_b64_tr_b16 v[64:65], v16 offset:0
    ds_read_b64_tr_b16 v[66:67], v16 offset:1024
    v_mfma_f32_32x32x16_bf16 v[128:143], v[48:51], v[84:87], v[128:143]
    ds_read_b128 v[36:39], v12 offset:4096
    ds_read_b64_tr_b16 v[68:69], v17 offset:0
    v_mfma_f32_32x32x16_bf16 v[144:159], v[52:55], v[84:87], v[144:159]
    ds_read_b64_tr_b16 v[70:71], v17 offset:1024
    ds_read_b128 v[40:43], v13 offset:0
    v_mfma_f32_32x32x16_bf16 v[96:111], v[56:59], v[88:91], v[96:111]
    ds_read_b64_tr_b16 v[72:73], v16 offset:4096
    ds_read_b64_tr_b16 v[74:75], v16 offset:5120
    v_mfma_f32_32x32x16_bf16 v[112:127], v[60:63], v[88:91], v[112:127]
    ds_read_b128 v[44:47], v13 offset:4096
    ds_read_b64_tr_b16 v[76:77], v17 offset:4096
    v_mfma_f32_32x32x16_bf16 v[128:143], v[56:59], v[92:95], v[128:143]
    ds_read_b64_tr_b16 v[78:79], v17 offset:5120
    s_add_u32 s35, s35, 1
    v_mfma_f32_32x32x16_bf16 v[144:159], v[60:63], v[92:95], v[144:159]
    s_cmp_lt_u32 s35, 10
    s_cbranch_scc1 K1_C_LOOP
    s_nop 7
    s_nop 3
    v_cvt_pk_bf16_f32 v32, v96, v97
    v_cvt_pk_bf16_f32 v33, v98, v99
    v_cvt_pk_bf16_f32 v34, v100, v101
    v_cvt_pk_bf16_f32 v35, v102, v103
    buffer_store_dwordx4 v[32:35], v160, s[20:23], s52 offen offset:0 sc1
    v_cvt_pk_bf16_f32 v36, v104, v105
    v_cvt_pk_bf16_f32 v37, v106, v107
    v_cvt_pk_bf16_f32 v38, v108, v109
    v_cvt_pk_bf16_f32 v39, v110, v111
    buffer_store_dwordx4 v[36:39], v160, s[20:23], s52 offen offset:640 sc1
    v_cvt_pk_bf16_f32 v40, v112, v113
    v_cvt_pk_bf16_f32 v41, v114, v115
    v_cvt_pk_bf16_f32 v42, v116, v117
    v_cvt_pk_bf16_f32 v43, v118, v119
    buffer_store_dwordx4 v[40:43], v160, s[20:23], s52 offen offset:1280 sc1
    v_cvt_pk_bf16_f32 v44, v120, v121
    v_cvt_pk_bf16_f32 v45, v122, v123
    v_cvt_pk_bf16_f32 v46, v124, v125
    v_cvt_pk_bf16_f32 v47, v126, v127
    buffer_store_dwordx4 v[44:47], v160, s[20:23], s52 offen offset:1920 sc1
    v_cvt_pk_bf16_f32 v48, v128, v129
    v_cvt_pk_bf16_f32 v49, v130, v131
    v_cvt_pk_bf16_f32 v50, v132, v133
    v_cvt_pk_bf16_f32 v51, v134, v135
    buffer_store_dwordx4 v[48:51], v161, s[20:23], s52 offen offset:0 sc1
    v_cvt_pk_bf16_f32 v52, v136, v137
    v_cvt_pk_bf16_f32 v53, v138, v139
    v_cvt_pk_bf16_f32 v54, v140, v141
    v_cvt_pk_bf16_f32 v55, v142, v143
    buffer_store_dwordx4 v[52:55], v161, s[20:23], s52 offen offset:640 sc1
    v_cvt_pk_bf16_f32 v56, v144, v145
    v_cvt_pk_bf16_f32 v57, v146, v147
    v_cvt_pk_bf16_f32 v58, v148, v149
    v_cvt_pk_bf16_f32 v59, v150, v151
    buffer_store_dwordx4 v[56:59], v161, s[20:23], s52 offen offset:1280 sc1
    v_cvt_pk_bf16_f32 v60, v152, v153
    v_cvt_pk_bf16_f32 v61, v154, v155
    v_cvt_pk_bf16_f32 v62, v156, v157
    v_cvt_pk_bf16_f32 v63, v158, v159
    buffer_store_dwordx4 v[60:63], v161, s[20:23], s52 offen offset:1920 sc1
    s_branch K1_FIN
K1_C_AND:
    v_mfma_f32_32x32x16_bf16 v[96:111], v[32:35], v[64:67], v[96:111]
    ds_read_b128 v[48:51], v14 offset:0
    ds_read_b64_tr_b16 v[80:81], v16 offset:8192
    ds_read_b64_tr_b16 v[82:83], v16 offset:9216
    v_mfma_f32_32x32x16_bf16 v[112:127], v[36:39], v[64:67], v[112:127]
    ds_read_b128 v[52:55], v14 offset:4096
    ds_read_b64_tr_b16 v[84:85], v17 offset:8192
    v_mfma_f32_32x32x16_bf16 v[128:143], v[32:35], v[68:71], v[128:143]
    ds_read_b64_tr_b16 v[86:87], v17 offset:9216
    ds_read_b128 v[56:59], v15 offset:0
    v_mfma_f32_32x32x16_bf16 v[144:159], v[36:39], v[68:71], v[144:159]
    ds_read_b64_tr_b16 v[88:89], v16 offset:12288
    ds_read_b64_tr_b16 v[90:91], v16 offset:13312
    v_mfma_f32_32x32x16_bf16 v[96:111], v[40:43], v[72:75], v[96:111]
    ds_read_b128 v[60:63], v15 offset:4096
    ds_read_b64_tr_b16 v[92:93], v17 offset:12288
    v_mfma_f32_32x32x16_bf16 v[112:127], v[44:47], v[72:75], v[112:127]
    ds_read_b64_tr_b16 v[94:95], v17 offset:13312
    s_add_u32 s36, s36, 49152
    s_cmp_eq_u32 s36, 147456
    s_cselect_b32 s36, 0, s36
    v_mfma_f32_32x32x16_bf16 v[128:143], v[40:43], v[76:79], v[128:143]
    v_mfma_f32_32x32x16_bf16 v[144:159], v[44:47], v[76:79], v[144:159]
    s_waitcnt vmcnt(0) lgkmcnt(0)
    s_branch K1_C_WB
K1_GATE:
    s_waitcnt lgkmcnt(0)
    s_mov_b32 s12, s8
    s_and_b32 s13, s9, 0xffff
    s_mov_b32 s14, 2621440
    s_mov_b32 s15, 0x00020000
    s_mov_b32 s24, s6
    s_and_b32 s25, s7, 0xffff
    s_mov_b32 s26, 1280
    s_mov_b32 s27, 0x00020000
    s_mov_b32 s20, s4
    s_and_b32 s21, s5, 0xffff
    s_mov_b32 s22, 37748736
    s_mov_b32 s23, 0x00020000
    v_lshlrev_b32 v19, 16, v1
    s_lshl_b32 s46, s32, 22
    s_cmp_lt_u32 s32, 6
    s_cbranch_scc0 K1_NOTLB
    buffer_load_dword v176, v19, s[20:23], s46 offen
K1_NOTLB:
    s_cmp_lg_u32 s2, 240
    s_cbranch_scc1 K1_NOZ
    s_cmp_ge_u32 s32, 4
    s_cbranch_scc1 K1_NOZ
    v_lshlrev_b32 v19, 7, v1
    v_mov_b32 v20, 0
    s_lshl_b32 s46, s32, 13
    s_add_u32 s46, s46, 15745024
    buffer_store_dword v20, v19, s[20:23], s46 offen
K1_NOZ:
    s_sub_u32 s46, s2, 240
    s_lshl_b32 s46, s46, 3
    s_add_u32 s46, s46, s32
    s_cmp_ge_u32 s46, 120
    s_cbranch_scc1 K1_GATE2
    s_mul_i32 s47, s46, 171
    s_lshr_b32 s47, s47, 9
    s_mul_i32 s48, s47, 3
    s_sub_u32 s48, s46, s48
    s_load_dwordx2 s[58:59], s[0:1], 16
    s_load_dwordx2 s[70:71], s[0:1], 40
    s_mul_i32 s53, s48, 448
    v_lshrrev_b32 v19, 5, v1
    v_mul_u32_u24 v19, 1280, v19
    v_and_b32 v20, 31, v1
    v_lshl_add_u32 v19, v20, 4, v19
    v_add_u32 v19, s53, v19
    s_lshl_b32 s52, s32, 14
    s_waitcnt lgkmcnt(0)
    s_mov_b32 s60, s58
    s_and_b32 s61, s59, 0xffff
    s_mov_b32 s62, 819200
    s_mov_b32 s63, 0x00020000
    s_mov_b32 s64, s70
    s_and_b32 s65, s71, 0xffff
    s_mov_b32 s66, 819200
    s_mov_b32 s67, 0x00020000
    s_lshl_b32 s72, s47, 2
    s_add_u32 s72, s72, 0
    s_mul_i32 s73, s72, 205
    s_lshr_b32 s73, s73, 10
    s_mul_i32 s74, s73, 5
    s_sub_u32 s74, s72, s74
    s_mul_i32 s73, s73, 20
    s_and_b32 s76, s74, 1
    s_lshl_b32 s76, s76, 3
    s_add_u32 s76, s76, 0
    s_lshr_b32 s77, s74, 1
    s_cmp_eq_u32 s74, 4
    s_cselect_b32 s76, 16, s76
    s_cselect_b32 s77, 0, s77
    s_add_u32 s76, s76, s73
    s_mul_i32 s76, s76, 1280
    s_cmp_eq_u32 s77, 0
    s_cbranch_scc0 K1_WB00
    s_add_u32 m0, s52, 0
    s_add_u32 s53, s76, 0
    buffer_load_dwordx4 v19, s[60:63], s53 offen lds
    s_add_u32 m0, s52, 1024
    s_add_u32 s53, s76, 2560
    buffer_load_dwordx4 v19, s[60:63], s53 offen lds
    s_branch K1_WD00
K1_WB00:
    s_add_u32 m0, s52, 0
    s_add_u32 s53, s76, 0
    buffer_load_dwordx4 v19, s[64:67], s53 offen lds
    s_add_u32 m0, s52, 1024
    s_add_u32 s53, s76, 2560
    buffer_load_dwordx4 v19, s[64:67], s53 offen lds
K1_WD00:
    s_and_b32 s76, s74, 1
    s_lshl_b32 s76, s76, 3
    s_add_u32 s76, s76, 4
    s_lshr_b32 s77, s74, 1
    s_cmp_eq_u32 s74, 4
    s_cselect_b32 s76, 16, s76
    s_cselect_b32 s77, 1, s77
    s_add_u32 s76, s76, s73
    s_mul_i32 s76, s76, 1280
    s_cmp_eq_u32 s77, 0
    s_cbranch_scc0 K1_WB01
    s_add_u32 m0, s52, 2048
    s_add_u32 s53, s76, 0
    buffer_load_dwordx4 v19, s[60:63], s53 offen lds
    s_add_u32 m0, s52, 3072
    s_add_u32 s53, s76, 2560
    buffer_load_dwordx4 v19, s[60:63], s53 offen lds
    s_branch K1_WD01
K1_WB01:
    s_add_u32 m0, s52, 2048
    s_add_u32 s53, s76, 0
    buffer_load_dwordx4 v19, s[64:67], s53 offen lds
    s_add_u32 m0, s52, 3072
    s_add_u32 s53, s76, 2560
    buffer_load_dwordx4 v19, s[64:67], s53 offen lds
K1_WD01:
    s_lshl_b32 s72, s47, 2
    s_add_u32 s72, s72, 1
    s_mul_i32 s73, s72, 205
    s_lshr_b32 s73, s73, 10
    s_mul_i32 s74, s73, 5
    s_sub_u32 s74, s72, s74
    s_mul_i32 s73, s73, 20
    s_and_b32 s76, s74, 1
    s_lshl_b32 s76, s76, 3
    s_add_u32 s76, s76, 0
    s_lshr_b32 s77, s74, 1
    s_cmp_eq_u32 s74, 4
    s_cselect_b32 s76, 16, s76
    s_cselect_b32 s77, 0, s77
    s_add_u32 s76, s76, s73
    s_mul_i32 s76, s76, 1280
    s_cmp_eq_u32 s77, 0
    s_cbranch_scc0 K1_WB10
    s_add_u32 m0, s52, 4096
    s_add_u32 s53, s76, 0
    buffer_load_dwordx4 v19, s[60:63], s53 offen lds
    s_add_u32 m0, s52, 5120
    s_add_u32 s53, s76, 2560
    buffer_load_dwordx4 v19, s[60:63], s53 offen lds
    s_branch K1_WD10
K1_WB10:
    s_add_u32 m0, s52, 4096
    s_add_u32 s53, s76, 0
    buffer_load_dwordx4 v19, s[64:67], s53 offen lds
    s_add_u32 m0, s52, 5120
    s_add_u32 s53, s76, 2560
    buffer_load_dwordx4 v19, s[64:67], s53 offen lds
K1_WD10:
    s_and_b32 s76, s74, 1
    s_lshl_b32 s76, s76, 3
    s_add_u32 s76, s76, 4
    s_lshr_b32 s77, s74, 1
    s_cmp_eq_u32 s74, 4
    s_cselect_b32 s76, 16, s76
    s_cselect_b32 s77, 1, s77
    s_add_u32 s76, s76, s73
    s_mul_i32 s76, s76, 1280
    s_cmp_eq_u32 s77, 0
    s_cbranch_scc0 K1_WB11
    s_add_u32 m0, s52, 6144
    s_add_u32 s53, s76, 0
    buffer_load_dwordx4 v19, s[60:63], s53 offen lds
    s_add_u32 m0, s52, 7168
    s_add_u32 s53, s76, 2560
    buffer_load_dwordx4 v19, s[60:63], s53 offen lds
    s_branch K1_WD11
K1_WB11:
    s_add_u32 m0, s52, 6144
    s_add_u32 s53, s76, 0
    buffer_load_dwordx4 v19, s[64:67], s53 offen lds
    s_add_u32 m0, s52, 7168
    s_add_u32 s53, s76, 2560
    buffer_load_dwordx4 v19, s[64:67], s53 offen lds
K1_WD11:
    s_lshl_b32 s72, s47, 2
    s_add_u32 s72, s72, 2
    s_mul_i32 s73, s72, 205
    s_lshr_b32 s73, s73, 10
    s_mul_i32 s74, s73, 5
    s_sub_u32 s74, s72, s74
    s_mul_i32 s73, s73, 20
    s_and_b32 s76, s74, 1
    s_lshl_b32 s76, s76, 3
    s_add_u32 s76, s76, 0
    s_lshr_b32 s77, s74, 1
    s_cmp_eq_u32 s74, 4
    s_cselect_b32 s76, 16, s76
    s_cselect_b32 s77, 0, s77
    s_add_u32 s76, s76, s73
    s_mul_i32 s76, s76, 1280
    s_cmp_eq_u32 s77, 0
    s_cbranch_scc0 K1_WB20
    s_add_u32 m0, s52, 8192
    s_add_u32 s53, s76, 0
    buffer_load_dwordx4 v19, s[60:63], s53 offen lds
    s_add_u32 m0, s52, 9216
    s_add_u32 s53, s76, 2560
    buffer_load_dwordx4 v19, s[60:63], s53 offen lds
    s_branch K1_WD20
K1_WB20:
    s_add_u32 m0, s52, 8192
    s_add_u32 s53, s76, 0
    buffer_load_dwordx4 v19, s[64:67], s53 offen lds
    s_add_u32 m0, s52, 9216
    s_add_u32 s53, s76, 2560
    buffer_load_dwordx4 v19, s[64:67], s53 offen lds
K1_WD20:
    s_and_b32 s76, s74, 1
    s_lshl_b32 s76, s76, 3
    s_add_u32 s76, s76, 4
    s_lshr_b32 s77, s74, 1
    s_cmp_eq_u32 s74, 4
    s_cselect_b32 s76, 16, s76
    s_cselect_b32 s77, 1, s77
    s_add_u32 s76, s76, s73
    s_mul_i32 s76, s76, 1280
    s_cmp_eq_u32 s77, 0
    s_cbranch_scc0 K1_WB21
    s_add_u32 m0, s52, 10240
    s_add_u32 s53, s76, 0
    buffer_load_dwordx4 v19, s[60:63], s53 offen lds
    s_add_u32 m0, s52, 11264
    s_add_u32 s53, s76, 2560
    buffer_load_dwordx4 v19, s[60:63], s53 offen lds
    s_branch K1_WD21
K1_WB21:
    s_add_u32 m0, s52, 10240
    s_add_u32 s53, s76, 0
    buffer_load_dwordx4 v19, s[64:67], s53 offen lds
    s_add_u32 m0, s52, 11264
    s_add_u32 s53, s76, 2560
    buffer_load_dwordx4 v19, s[64:67], s53 offen lds
K1_WD21:
    s_lshl_b32 s72, s47, 2
    s_add_u32 s72, s72, 3
    s_mul_i32 s73, s72, 205
    s_lshr_b32 s73, s73, 10
    s_mul_i32 s74, s73, 5
    s_sub_u32 s74, s72, s74
    s_mul_i32 s73, s73, 20
    s_and_b32 s76, s74, 1
    s_lshl_b32 s76, s76, 3
    s_add_u32 s76, s76, 0
    s_lshr_b32 s77, s74, 1
    s_cmp_eq_u32 s74, 4
    s_cselect_b32 s76, 16, s76
    s_cselect_b32 s77, 0, s77
    s_add_u32 s76, s76, s73
    s_mul_i32 s76, s76, 1280
    s_cmp_eq_u32 s77, 0
    s_cbranch_scc0 K1_WB30
    s_add_u32 m0, s52, 12288
    s_add_u32 s53, s76, 0
    buffer_load_dwordx4 v19, s[60:63], s53 offen lds
    s_add_u32 m0, s52, 13312
    s_add_u32 s53, s76, 2560
    buffer_load_dwordx4 v19, s[60:63], s53 offen lds
    s_branch K1_WD30
K1_WB30:
    s_add_u32 m0, s52, 12288
    s_add_u32 s53, s76, 0
    buffer_load_dwordx4 v19, s[64:67], s53 offen lds
    s_add_u32 m0, s52, 13312
    s_add_u32 s53, s76, 2560
    buffer_load_dwordx4 v19, s[64:67], s53 offen lds
K1_WD30:
    s_and_b32 s76, s74, 1
    s_lshl_b32 s76, s76, 3
    s_add_u32 s76, s76, 4
    s_lshr_b32 s77, s74, 1
    s_cmp_eq_u32 s74, 4
    s_cselect_b32 s76, 16, s76
    s_cselect_b32 s77, 1, s77
    s_add_u32 s76, s76, s73
    s_mul_i32 s76, s76, 1280
    s_cmp_eq_u32 s77, 0
    s_cbranch_scc0 K1_WB31
    s_add_u32 m0, s52, 14336
    s_add_u32 s53, s76, 0
    buffer_load_dwordx4 v19, s[60:63], s53 offen lds
    s_add_u32 m0, s52, 15360
    s_add_u32 s53, s76, 2560
    buffer_load_dwordx4 v19, s[60:63], s53 offen lds
    s_branch K1_WD31
K1_WB31:
    s_add_u32 m0, s52, 14336
    s_add_u32 s53, s76, 0
    buffer_load_dwordx4 v19, s[64:67], s53 offen lds
    s_add_u32 m0, s52, 15360
    s_add_u32 s53, s76, 2560
    buffer_load_dwordx4 v19, s[64:67], s53 offen lds
K1_WD31:
    v_lshrrev_b32 v20, 4, v1
    v_bfe_u32 v21, v1, 2, 2
    v_lshl_add_u32 v20, v20, 3, v21
    v_lshlrev_b32 v20, 9, v20
    v_and_b32 v21, 3, v1
    v_lshl_add_u32 v20, v21, 3, v20
    v_add_u32 v20, s52, v20
    v_lshlrev_b32 v21, 4, v1
    s_waitcnt vmcnt(0)
    ds_read_b64_tr_b16 v[32:33], v20 offset:0
    ds_read_b64_tr_b16 v[34:35], v20 offset:2048
    ds_read_b64_tr_b16 v[36:37], v20 offset:32
    ds_read_b64_tr_b16 v[38:39], v20 offset:2080
    ds_read_b64_tr_b16 v[40:41], v20 offset:64
    ds_read_b64_tr_b16 v[42:43], v20 offset:2112
    ds_read_b64_tr_b16 v[44:45], v20 offset:96
    ds_read_b64_tr_b16 v[46:47], v20 offset:2144
    ds_read_b64_tr_b16 v[48:49], v20 offset:128
    ds_read_b64_tr_b16 v[50:51], v20 offset:2176
    ds_read_b64_tr_b16 v[52:53], v20 offset:160
    ds_read_b64_tr_b16 v[54:55], v20 offset:2208
    ds_read_b64_tr_b16 v[56:57], v20 offset:192
    ds_read_b64_tr_b16 v[58:59], v20 offset:2240
    ds_read_b64_tr_b16 v[60:61], v20 offset:224
    ds_read_b64_tr_b16 v[62:63], v20 offset:2272
    ds_read_b64_tr_b16 v[64:65], v20 offset:256
    ds_read_b64_tr_b16 v[66:67], v20 offset:2304
    ds_read_b64_tr_b16 v[68:69], v20 offset:288
    ds_read_b64_tr_b16 v[70:71], v20 offset:2336
    ds_read_b64_tr_b16 v[72:73], v20 offset:320
    ds_read_b64_tr_b16 v[74:75], v20 offset:2368
    ds_read_b64_tr_b16 v[76:77], v20 offset:352
    ds_read_b64_tr_b16 v[78:79], v20 offset:2400
    ds_read_b64_tr_b16 v[80:81], v20 offset:384
    ds_read_b64_tr_b16 v[82:83], v20 offset:2432
    ds_read_b64_tr_b16 v[84:85], v20 offset:416
    ds_read_b64_tr_b16 v[86:87], v20 offset:2464
    s_mul_i32 s48, s48, 14
    s_waitcnt lgkmcnt(0)
    s_add_u32 s49, s48, 0
    s_cmp_ge_u32 s49, 40
    s_cbranch_scc1 K1_GATE2
    s_mul_i32 s53, s49, 52
    s_lshr_b32 s53, s53, 8
    s_mul_i32 s52, s53, 5
    s_sub_u32 s52, s49, s52
    s_mul_i32 s53, s53, 40
    s_add_u32 s53, s53, s47
    s_mul_i32 s53, s53, 5
    s_add_u32 s53, s53, s52
    s_lshl_b32 s53, s53, 10
    s_add_u32 s53, s53, 15794176
    buffer_store_dwordx4 v[32:35], v21, s[20:23], s53 offen
    s_add_u32 s49, s48, 1
    s_cmp_ge_u32 s49, 40
    s_cbranch_scc1 K1_GATE2
    s_mul_i32 s53, s49, 52
    s_lshr_b32 s53, s53, 8
    s_mul_i32 s52, s53, 5
    s_sub_u32 s52, s49, s52
    s_mul_i32 s53, s53, 40
    s_add_u32 s53, s53, s47
    s_mul_i32 s53, s53, 5
    s_add_u32 s53, s53, s52
    s_lshl_b32 s53, s53, 10
    s_add_u32 s53, s53, 15794176
    buffer_store_dwordx4 v[36:39], v21, s[20:23], s53 offen
    s_add_u32 s49, s48, 2
    s_cmp_ge_u32 s49, 40
    s_cbranch_scc1 K1_GATE2
    s_mul_i32 s53, s49, 52
    s_lshr_b32 s53, s53, 8
    s_mul_i32 s52, s53, 5
    s_sub_u32 s52, s49, s52
    s_mul_i32 s53, s53, 40
    s_add_u32 s53, s53, s47
    s_mul_i32 s53, s53, 5
    s_add_u32 s53, s53, s52
    s_lshl_b32 s53, s53, 10
    s_add_u32 s53, s53, 15794176
    buffer_store_dwordx4 v[40:43], v21, s[20:23], s53 offen
    s_add_u32 s49, s48, 3
    s_cmp_ge_u32 s49, 40
    s_cbranch_scc1 K1_GATE2
    s_mul_i32 s53, s49, 52
    s_lshr_b32 s53, s53, 8
    s_mul_i32 s52, s53, 5
    s_sub_u32 s52, s49, s52
    s_mul_i32 s53, s53, 40
    s_add_u32 s53, s53, s47
    s_mul_i32 s53, s53, 5
    s_add_u32 s53, s53, s52
    s_lshl_b32 s53, s53, 10
    s_add_u32 s53, s53, 15794176
    buffer_store_dwordx4 v[44:47], v21, s[20:23], s53 offen
    s_add_u32 s49, s48, 4
    s_cmp_ge_u32 s49, 40
    s_cbranch_scc1 K1_GATE2
    s_mul_i32 s53, s49, 52
    s_lshr_b32 s53, s53, 8
    s_mul_i32 s52, s53, 5
    s_sub_u32 s52, s49, s52
    s_mul_i32 s53, s53, 40
    s_add_u32 s53, s53, s47
    s_mul_i32 s53, s53, 5
    s_add_u32 s53, s53, s52
    s_lshl_b32 s53, s53, 10
    s_add_u32 s53, s53, 15794176
    buffer_store_dwordx4 v[48:51], v21, s[20:23], s53 offen
    s_add_u32 s49, s48, 5
    s_cmp_ge_u32 s49, 40
    s_cbranch_scc1 K1_GATE2
    s_mul_i32 s53, s49, 52
    s_lshr_b32 s53, s53, 8
    s_mul_i32 s52, s53, 5
    s_sub_u32 s52, s49, s52
    s_mul_i32 s53, s53, 40
    s_add_u32 s53, s53, s47
    s_mul_i32 s53, s53, 5
    s_add_u32 s53, s53, s52
    s_lshl_b32 s53, s53, 10
    s_add_u32 s53, s53, 15794176
    buffer_store_dwordx4 v[52:55], v21, s[20:23], s53 offen
    s_add_u32 s49, s48, 6
    s_cmp_ge_u32 s49, 40
    s_cbranch_scc1 K1_GATE2
    s_mul_i32 s53, s49, 52
    s_lshr_b32 s53, s53, 8
    s_mul_i32 s52, s53, 5
    s_sub_u32 s52, s49, s52
    s_mul_i32 s53, s53, 40
    s_add_u32 s53, s53, s47
    s_mul_i32 s53, s53, 5
    s_add_u32 s53, s53, s52
    s_lshl_b32 s53, s53, 10
    s_add_u32 s53, s53, 15794176
    buffer_store_dwordx4 v[56:59], v21, s[20:23], s53 offen
    s_add_u32 s49, s48, 7
    s_cmp_ge_u32 s49, 40
    s_cbranch_scc1 K1_GATE2
    s_mul_i32 s53, s49, 52
    s_lshr_b32 s53, s53, 8
    s_mul_i32 s52, s53, 5
    s_sub_u32 s52, s49, s52
    s_mul_i32 s53, s53, 40
    s_add_u32 s53, s53, s47
    s_mul_i32 s53, s53, 5
    s_add_u32 s53, s53, s52
    s_lshl_b32 s53, s53, 10
    s_add_u32 s53, s53, 15794176
    buffer_store_dwordx4 v[60:63], v21, s[20:23], s53 offen
    s_add_u32 s49, s48, 8
    s_cmp_ge_u32 s49, 40
    s_cbranch_scc1 K1_GATE2
    s_mul_i32 s53, s49, 52
    s_lshr_b32 s53, s53, 8
    s_mul_i32 s52, s53, 5
    s_sub_u32 s52, s49, s52
    s_mul_i32 s53, s53, 40
    s_add_u32 s53, s53, s47
    s_mul_i32 s53, s53, 5
    s_add_u32 s53, s53, s52
    s_lshl_b32 s53, s53, 10
    s_add_u32 s53, s53, 15794176
    buffer_store_dwordx4 v[64:67], v21, s[20:23], s53 offen
    s_add_u32 s49, s48, 9
    s_cmp_ge_u32 s49, 40
    s_cbranch_scc1 K1_GATE2
    s_mul_i32 s53, s49, 52
    s_lshr_b32 s53, s53, 8
    s_mul_i32 s52, s53, 5
    s_sub_u32 s52, s49, s52
    s_mul_i32 s53, s53, 40
    s_add_u32 s53, s53, s47
    s_mul_i32 s53, s53, 5
    s_add_u32 s53, s53, s52
    s_lshl_b32 s53, s53, 10
    s_add_u32 s53, s53, 15794176
    buffer_store_dwordx4 v[68:71], v21, s[20:23], s53 offen
    s_add_u32 s49, s48, 10
    s_cmp_ge_u32 s49, 40
    s_cbranch_scc1 K1_GATE2
    s_mul_i32 s53, s49, 52
    s_lshr_b32 s53, s53, 8
    s_mul_i32 s52, s53, 5
    s_sub_u32 s52, s49, s52
    s_mul_i32 s53, s53, 40
    s_add_u32 s53, s53, s47
    s_mul_i32 s53, s53, 5
    s_add_u32 s53, s53, s52
    s_lshl_b32 s53, s53, 10
    s_add_u32 s53, s53, 15794176
    buffer_store_dwordx4 v[72:75], v21, s[20:23], s53 offen
    s_add_u32 s49, s48, 11
    s_cmp_ge_u32 s49, 40
    s_cbranch_scc1 K1_GATE2
    s_mul_i32 s53, s49, 52
    s_lshr_b32 s53, s53, 8
    s_mul_i32 s52, s53, 5
    s_sub_u32 s52, s49, s52
    s_mul_i32 s53, s53, 40
    s_add_u32 s53, s53, s47
    s_mul_i32 s53, s53, 5
    s_add_u32 s53, s53, s52
    s_lshl_b32 s53, s53, 10
    s_add_u32 s53, s53, 15794176
    buffer_store_dwordx4 v[76:79], v21, s[20:23], s53 offen
    s_add_u32 s49, s48, 12
    s_cmp_ge_u32 s49, 40
    s_cbranch_scc1 K1_GATE2
    s_mul_i32 s53, s49, 52
    s_lshr_b32 s53, s53, 8
    s_mul_i32 s52, s53, 5
    s_sub_u32 s52, s49, s52
    s_mul_i32 s53, s53, 40
    s_add_u32 s53, s53, s47
    s_mul_i32 s53, s53, 5
    s_add_u32 s53, s53, s52
    s_lshl_b32 s53, s53, 10
    s_add_u32 s53, s53, 15794176
    buffer_store_dwordx4 v[80:83], v21, s[20:23], s53 offen
    s_add_u32 s49, s48, 13
    s_cmp_ge_u32 s49, 40
    s_cbranch_scc1 K1_GATE2
    s_mul_i32 s53, s49, 52
    s_lshr_b32 s53, s53, 8
    s_mul_i32 s52, s53, 5
    s_sub_u32 s52, s49, s52
    s_mul_i32 s53, s53, 40
    s_add_u32 s53, s53, s47
    s_mul_i32 s53, s53, 5
    s_add_u32 s53, s53, s52
    s_lshl_b32 s53, s53, 10
    s_add_u32 s53, s53, 15794176
    buffer_store_dwordx4 v[84:87], v21, s[20:23], s53 offen
K1_GATE2:
    s_nop 1
    s_sub_u32 s46, s2, 240
    s_lshl_b32 s46, s46, 7
    s_lshl_b32 s47, s32, 4
    s_add_u32 s35, s46, s47
    v_lshlrev_b32 v18, 2, v1
    buffer_load_dword v25, v18, s[24:27], 0 offen offset:0
    buffer_load_dword v26, v18, s[24:27], 0 offen offset:256
    buffer_load_dword v27, v18, s[24:27], 0 offen offset:512
    buffer_load_dword v28, v18, s[24:27], 0 offen offset:768
    buffer_load_dword v29, v18, s[24:27], 0 offen offset:1024
    s_mul_i32 s49, s35, 1280
    buffer_load_dword v32, v18, s[12:15], s49 offen offset:0
    buffer_load_dword v33, v18, s[12:15], s49 offen offset:256
    buffer_load_dword v34, v18, s[12:15], s49 offen offset:512
    buffer_load_dword v35, v18, s[12:15], s49 offen offset:768
    buffer_load_dword v36, v18, s[12:15], s49 offen offset:1024
    s_add_u32 s49, s49, 1280
    buffer_load_dword v37, v18, s[12:15], s49 offen offset:0
    buffer_load_dword v38, v18, s[12:15], s49 offen offset:256
    buffer_load_dword v39, v18, s[12:15], s49 offen offset:512
    buffer_load_dword v40, v18, s[12:15], s49 offen offset:768
    buffer_load_dword v41, v18, s[12:15], s49 offen offset:1024
    s_add_u32 s49, s49, 1280
    buffer_load_dword v42, v18, s[12:15], s49 offen offset:0
    buffer_load_dword v43, v18, s[12:15], s49 offen offset:256
    buffer_load_dword v44, v18, s[12:15], s49 offen offset:512
    buffer_load_dword v45, v18, s[12:15], s49 offen offset:768
    buffer_load_dword v46, v18, s[12:15], s49 offen offset:1024
    s_add_u32 s49, s49, 1280
    buffer_load_dword v47, v18, s[12:15], s49 offen offset:0
    buffer_load_dword v48, v18, s[12:15], s49 offen offset:256
    buffer_load_dword v49, v18, s[12:15], s49 offen offset:512
    buffer_load_dword v50, v18, s[12:15], s49 offen offset:768
    buffer_load_dword v51, v18, s[12:15], s49 offen offset:1024
    s_add_u32 s49, s49, 1280
    buffer_load_dword v52, v18, s[12:15], s49 offen offset:0
    buffer_load_dword v53, v18, s[12:15], s49 offen offset:256
    buffer_load_dword v54, v18, s[12:15], s49 offen offset:512
    buffer_load_dword v55, v18, s[12:15], s49 offen offset:768
    buffer_load_dword v56, v18, s[12:15], s49 offen offset:1024
    s_add_u32 s49, s49, 1280
    buffer_load_dword v57, v18, s[12:15], s49 offen offset:0
    buffer_load_dword v58, v18, s[12:15], s49 offen offset:256
    buffer_load_dword v59, v18, s[12:15], s49 offen offset:512
    buffer_load_dword v60, v18, s[12:15], s49 offen offset:768
    buffer_load_dword v61, v18, s[12:15], s49 offen offset:1024
    s_add_u32 s49, s49, 1280
    buffer_load_dword v62, v18, s[12:15], s49 offen offset:0
    buffer_load_dword v63, v18, s[12:15], s49 offen offset:256
    buffer_load_dword v64, v18, s[12:15], s49 offen offset:512
    buffer_load_dword v65, v18, s[12:15], s49 offen offset:768
    buffer_load_dword v66, v18, s[12:15], s49 offen offset:1024
    s_add_u32 s49, s49, 1280
    buffer_load_dword v67, v18, s[12:15], s49 offen offset:0
    buffer_load_dword v68, v18, s[12:15], s49 offen offset:256
    buffer_load_dword v69, v18, s[12:15], s49 offen offset:512
    buffer_load_dword v70, v18, s[12:15], s49 offen offset:768
    buffer_load_dword v71, v18, s[12:15], s49 offen offset:1024
    s_add_u32 s49, s49, 1280
    buffer_load_dword v72, v18, s[12:15], s49 offen offset:0
    buffer_load_dword v73, v18, s[12:15], s49 offen offset:256
    buffer_load_dword v74, v18, s[12:15], s49 offen offset:512
    buffer_load_dword v75, v18, s[12:15], s49 offen offset:768
    buffer_load_dword v76, v18, s[12:15], s49 offen offset:1024
    s_add_u32 s49, s49, 1280
    buffer_load_dword v77, v18, s[12:15], s49 offen offset:0
    buffer_load_dword v78, v18, s[12:15], s49 offen offset:256
    buffer_load_dword v79, v18, s[12:15], s49 offen offset:512
    buffer_load_dword v80, v18, s[12:15], s49 offen offset:768
    buffer_load_dword v81, v18, s[12:15], s49 offen offset:1024
    s_add_u32 s49, s49, 1280
    s_waitcnt vmcnt(20)
    buffer_load_dword v82, v18, s[12:15], s49 offen offset:0
    buffer_load_dword v83, v18, s[12:15], s49 offen offset:256
    buffer_load_dword v84, v18, s[12:15], s49 offen offset:512
    buffer_load_dword v85, v18, s[12:15], s49 offen offset:768
    buffer_load_dword v86, v18, s[12:15], s49 offen offset:1024
    s_add_u32 s49, s49, 1280
    buffer_load_dword v87, v18, s[12:15], s49 offen offset:0
    buffer_load_dword v88, v18, s[12:15], s49 offen offset:256
    buffer_load_dword v89, v18, s[12:15], s49 offen offset:512
    buffer_load_dword v90, v18, s[12:15], s49 offen offset:768
    buffer_load_dword v91, v18, s[12:15], s49 offen offset:1024
    s_add_u32 s49, s49, 1280
    buffer_load_dword v92, v18, s[12:15], s49 offen offset:0
    buffer_load_dword v93, v18, s[12:15], s49 offen offset:256
    buffer_load_dword v94, v18, s[12:15], s49 offen offset:512
    buffer_load_dword v95, v18, s[12:15], s49 offen offset:768
    buffer_load_dword v96, v18, s[12:15], s49 offen offset:1024
    s_add_u32 s49, s49, 1280
    buffer_load_dword v97, v18, s[12:15], s49 offen offset:0
    buffer_load_dword v98, v18, s[12:15], s49 offen offset:256
    buffer_load_dword v99, v18, s[12:15], s49 offen offset:512
    buffer_load_dword v100, v18, s[12:15], s49 offen offset:768
    buffer_load_dword v101, v18, s[12:15], s49 offen offset:1024
    s_add_u32 s49, s49, 1280
    buffer_load_dword v102, v18, s[12:15], s49 offen offset:0
    buffer_load_dword v103, v18, s[12:15], s49 offen offset:256
    buffer_load_dword v104, v18, s[12:15], s49 offen offset:512
    buffer_load_dword v105, v18, s[12:15], s49 offen offset:768
    buffer_load_dword v106, v18, s[12:15], s49 offen offset:1024
    s_add_u32 s49, s49, 1280
    buffer_load_dword v107, v18, s[12:15], s49 offen offset:0
    buffer_load_dword v108, v18, s[12:15], s49 offen offset:256
    buffer_load_dword v109, v18, s[12:15], s49 offen offset:512
    buffer_load_dword v110, v18, s[12:15], s49 offen offset:768
    buffer_load_dword v111, v18, s[12:15], s49 offen offset:1024
    s_add_u32 s49, s49, 1280
    s_waitcnt vmcnt(0)
    v_lshlrev_b32 v20, 16, v25
    v_and_b32 v25, 0xffff0000, v25
    v_lshlrev_b32 v21, 16, v26
    v_and_b32 v26, 0xffff0000, v26
    v_lshlrev_b32 v22, 16, v27
    v_and_b32 v27, 0xffff0000, v27
    v_lshlrev_b32 v23, 16, v28
    v_and_b32 v28, 0xffff0000, v28
    v_lshlrev_b32 v24, 16, v29
    v_and_b32 v29, 0xffff0000, v29
    v_mov_b32 v112, 0
    v_lshlrev_b32 v18, 16, v32
    v_and_b32 v32, 0xffff0000, v32
    v_fmac_f32 v112, v18, v20
    v_fmac_f32 v112, v32, v25
    v_lshlrev_b32 v18, 16, v33
    v_and_b32 v33, 0xffff0000, v33
    v_fmac_f32 v112, v18, v21
    v_fmac_f32 v112, v33, v26
    v_lshlrev_b32 v18, 16, v34
    v_and_b32 v34, 0xffff0000, v34
    v_fmac_f32 v112, v18, v22
    v_fmac_f32 v112, v34, v27
    v_lshlrev_b32 v18, 16, v35
    v_and_b32 v35, 0xffff0000, v35
    v_fmac_f32 v112, v18, v23
    v_fmac_f32 v112, v35, v28
    v_lshlrev_b32 v18, 16, v36
    v_and_b32 v36, 0xffff0000, v36
    v_fmac_f32 v112, v18, v24
    v_fmac_f32 v112, v36, v29
    v_mov_b32 v113, 0
    v_lshlrev_b32 v18, 16, v37
    v_and_b32 v37, 0xffff0000, v37
    v_fmac_f32 v113, v18, v20
    v_fmac_f32 v113, v37, v25
    v_lshlrev_b32 v18, 16, v38
    v_and_b32 v38, 0xffff0000, v38
    v_fmac_f32 v113, v18, v21
    v_fmac_f32 v113, v38, v26
    v_lshlrev_b32 v18, 16, v39
    v_and_b32 v39, 0xffff0000, v39
    v_fmac_f32 v113, v18, v22
    v_fmac_f32 v113, v39, v27
    v_lshlrev_b32 v18, 16, v40
    v_and_b32 v40, 0xffff0000, v40
    v_fmac_f32 v113, v18, v23
    v_fmac_f32 v113, v40, v28
    v_lshlrev_b32 v18, 16, v41
    v_and_b32 v41, 0xffff0000, v41
    v_fmac_f32 v113, v18, v24
    v_fmac_f32 v113, v41, v29
    v_mov_b32 v114, 0
    v_lshlrev_b32 v18, 16, v42
    v_and_b32 v42, 0xffff0000, v42
    v_fmac_f32 v114, v18, v20
    v_fmac_f32 v114, v42, v25
    v_lshlrev_b32 v18, 16, v43
    v_and_b32 v43, 0xffff0000, v43
    v_fmac_f32 v114, v18, v21
    v_fmac_f32 v114, v43, v26
    v_lshlrev_b32 v18, 16, v44
    v_and_b32 v44, 0xffff0000, v44
    v_fmac_f32 v114, v18, v22
    v_fmac_f32 v114, v44, v27
    v_lshlrev_b32 v18, 16, v45
    v_and_b32 v45, 0xffff0000, v45
    v_fmac_f32 v114, v18, v23
    v_fmac_f32 v114, v45, v28
    v_lshlrev_b32 v18, 16, v46
    v_and_b32 v46, 0xffff0000, v46
    v_fmac_f32 v114, v18, v24
    v_fmac_f32 v114, v46, v29
    v_mov_b32 v115, 0
    v_lshlrev_b32 v18, 16, v47
    v_and_b32 v47, 0xffff0000, v47
    v_fmac_f32 v115, v18, v20
    v_fmac_f32 v115, v47, v25
    v_lshlrev_b32 v18, 16, v48
    v_and_b32 v48, 0xffff0000, v48
    v_fmac_f32 v115, v18, v21
    v_fmac_f32 v115, v48, v26
    v_lshlrev_b32 v18, 16, v49
    v_and_b32 v49, 0xffff0000, v49
    v_fmac_f32 v115, v18, v22
    v_fmac_f32 v115, v49, v27
    v_lshlrev_b32 v18, 16, v50
    v_and_b32 v50, 0xffff0000, v50
    v_fmac_f32 v115, v18, v23
    v_fmac_f32 v115, v50, v28
    v_lshlrev_b32 v18, 16, v51
    v_and_b32 v51, 0xffff0000, v51
    v_fmac_f32 v115, v18, v24
    v_fmac_f32 v115, v51, v29
    v_mov_b32 v116, 0
    v_lshlrev_b32 v18, 16, v52
    v_and_b32 v52, 0xffff0000, v52
    v_fmac_f32 v116, v18, v20
    v_fmac_f32 v116, v52, v25
    v_lshlrev_b32 v18, 16, v53
    v_and_b32 v53, 0xffff0000, v53
    v_fmac_f32 v116, v18, v21
    v_fmac_f32 v116, v53, v26
    v_lshlrev_b32 v18, 16, v54
    v_and_b32 v54, 0xffff0000, v54
    v_fmac_f32 v116, v18, v22
    v_fmac_f32 v116, v54, v27
    v_lshlrev_b32 v18, 16, v55
    v_and_b32 v55, 0xffff0000, v55
    v_fmac_f32 v116, v18, v23
    v_fmac_f32 v116, v55, v28
    v_lshlrev_b32 v18, 16, v56
    v_and_b32 v56, 0xffff0000, v56
    v_fmac_f32 v116, v18, v24
    v_fmac_f32 v116, v56, v29
    v_mov_b32 v117, 0
    v_lshlrev_b32 v18, 16, v57
    v_and_b32 v57, 0xffff0000, v57
    v_fmac_f32 v117, v18, v20
    v_fmac_f32 v117, v57, v25
    v_lshlrev_b32 v18, 16, v58
    v_and_b32 v58, 0xffff0000, v58
    v_fmac_f32 v117, v18, v21
    v_fmac_f32 v117, v58, v26
    v_lshlrev_b32 v18, 16, v59
    v_and_b32 v59, 0xffff0000, v59
    v_fmac_f32 v117, v18, v22
    v_fmac_f32 v117, v59, v27
    v_lshlrev_b32 v18, 16, v60
    v_and_b32 v60, 0xffff0000, v60
    v_fmac_f32 v117, v18, v23
    v_fmac_f32 v117, v60, v28
    v_lshlrev_b32 v18, 16, v61
    v_and_b32 v61, 0xffff0000, v61
    v_fmac_f32 v117, v18, v24
    v_fmac_f32 v117, v61, v29
    v_mov_b32 v118, 0
    v_lshlrev_b32 v18, 16, v62
    v_and_b32 v62, 0xffff0000, v62
    v_fmac_f32 v118, v18, v20
    v_fmac_f32 v118, v62, v25
    v_lshlrev_b32 v18, 16, v63
    v_and_b32 v63, 0xffff0000, v63
    v_fmac_f32 v118, v18, v21
    v_fmac_f32 v118, v63, v26
    v_lshlrev_b32 v18, 16, v64
    v_and_b32 v64, 0xffff0000, v64
    v_fmac_f32 v118, v18, v22
    v_fmac_f32 v118, v64, v27
    v_lshlrev_b32 v18, 16, v65
    v_and_b32 v65, 0xffff0000, v65
    v_fmac_f32 v118, v18, v23
    v_fmac_f32 v118, v65, v28
    v_lshlrev_b32 v18, 16, v66
    v_and_b32 v66, 0xffff0000, v66
    v_fmac_f32 v118, v18, v24
    v_fmac_f32 v118, v66, v29
    v_mov_b32 v119, 0
    v_lshlrev_b32 v18, 16, v67
    v_and_b32 v67, 0xffff0000, v67
    v_fmac_f32 v119, v18, v20
    v_fmac_f32 v119, v67, v25
    v_lshlrev_b32 v18, 16, v68
    v_and_b32 v68, 0xffff0000, v68
    v_fmac_f32 v119, v18, v21
    v_fmac_f32 v119, v68, v26
    v_lshlrev_b32 v18, 16, v69
    v_and_b32 v69, 0xffff0000, v69
    v_fmac_f32 v119, v18, v22
    v_fmac_f32 v119, v69, v27
    v_lshlrev_b32 v18, 16, v70
    v_and_b32 v70, 0xffff0000, v70
    v_fmac_f32 v119, v18, v23
    v_fmac_f32 v119, v70, v28
    v_lshlrev_b32 v18, 16, v71
    v_and_b32 v71, 0xffff0000, v71
    v_fmac_f32 v119, v18, v24
    v_fmac_f32 v119, v71, v29
    v_mov_b32 v120, 0
    v_lshlrev_b32 v18, 16, v72
    v_and_b32 v72, 0xffff0000, v72
    v_fmac_f32 v120, v18, v20
    v_fmac_f32 v120, v72, v25
    v_lshlrev_b32 v18, 16, v73
    v_and_b32 v73, 0xffff0000, v73
    v_fmac_f32 v120, v18, v21
    v_fmac_f32 v120, v73, v26
    v_lshlrev_b32 v18, 16, v74
    v_and_b32 v74, 0xffff0000, v74
    v_fmac_f32 v120, v18, v22
    v_fmac_f32 v120, v74, v27
    v_lshlrev_b32 v18, 16, v75
    v_and_b32 v75, 0xffff0000, v75
    v_fmac_f32 v120, v18, v23
    v_fmac_f32 v120, v75, v28
    v_lshlrev_b32 v18, 16, v76
    v_and_b32 v76, 0xffff0000, v76
    v_fmac_f32 v120, v18, v24
    v_fmac_f32 v120, v76, v29
    v_mov_b32 v121, 0
    v_lshlrev_b32 v18, 16, v77
    v_and_b32 v77, 0xffff0000, v77
    v_fmac_f32 v121, v18, v20
    v_fmac_f32 v121, v77, v25
    v_lshlrev_b32 v18, 16, v78
    v_and_b32 v78, 0xffff0000, v78
    v_fmac_f32 v121, v18, v21
    v_fmac_f32 v121, v78, v26
    v_lshlrev_b32 v18, 16, v79
    v_and_b32 v79, 0xffff0000, v79
    v_fmac_f32 v121, v18, v22
    v_fmac_f32 v121, v79, v27
    v_lshlrev_b32 v18, 16, v80
    v_and_b32 v80, 0xffff0000, v80
    v_fmac_f32 v121, v18, v23
    v_fmac_f32 v121, v80, v28
    v_lshlrev_b32 v18, 16, v81
    v_and_b32 v81, 0xffff0000, v81
    v_fmac_f32 v121, v18, v24
    v_fmac_f32 v121, v81, v29
    v_mov_b32 v122, 0
    v_lshlrev_b32 v18, 16, v82
    v_and_b32 v82, 0xffff0000, v82
    v_fmac_f32 v122, v18, v20
    v_fmac_f32 v122, v82, v25
    v_lshlrev_b32 v18, 16, v83
    v_and_b32 v83, 0xffff0000, v83
    v_fmac_f32 v122, v18, v21
    v_fmac_f32 v122, v83, v26
    v_lshlrev_b32 v18, 16, v84
    v_and_b32 v84, 0xffff0000, v84
    v_fmac_f32 v122, v18, v22
    v_fmac_f32 v122, v84, v27
    v_lshlrev_b32 v18, 16, v85
    v_and_b32 v85, 0xffff0000, v85
    v_fmac_f32 v122, v18, v23
    v_fmac_f32 v122, v85, v28
    v_lshlrev_b32 v18, 16, v86
    v_and_b32 v86, 0xffff0000, v86
    v_fmac_f32 v122, v18, v24
    v_fmac_f32 v122, v86, v29
    v_mov_b32 v123, 0
    v_lshlrev_b32 v18, 16, v87
    v_and_b32 v87, 0xffff0000, v87
    v_fmac_f32 v123, v18, v20
    v_fmac_f32 v123, v87, v25
    v_lshlrev_b32 v18, 16, v88
    v_and_b32 v88, 0xffff0000, v88
    v_fmac_f32 v123, v18, v21
    v_fmac_f32 v123, v88, v26
    v_lshlrev_b32 v18, 16, v89
    v_and_b32 v89, 0xffff0000, v89
    v_fmac_f32 v123, v18, v22
    v_fmac_f32 v123, v89, v27
    v_lshlrev_b32 v18, 16, v90
    v_and_b32 v90, 0xffff0000, v90
    v_fmac_f32 v123, v18, v23
    v_fmac_f32 v123, v90, v28
    v_lshlrev_b32 v18, 16, v91
    v_and_b32 v91, 0xffff0000, v91
    v_fmac_f32 v123, v18, v24
    v_fmac_f32 v123, v91, v29
    v_mov_b32 v124, 0
    v_lshlrev_b32 v18, 16, v92
    v_and_b32 v92, 0xffff0000, v92
    v_fmac_f32 v124, v18, v20
    v_fmac_f32 v124, v92, v25
    v_lshlrev_b32 v18, 16, v93
    v_and_b32 v93, 0xffff0000, v93
    v_fmac_f32 v124, v18, v21
    v_fmac_f32 v124, v93, v26
    v_lshlrev_b32 v18, 16, v94
    v_and_b32 v94, 0xffff0000, v94
    v_fmac_f32 v124, v18, v22
    v_fmac_f32 v124, v94, v27
    v_lshlrev_b32 v18, 16, v95
    v_and_b32 v95, 0xffff0000, v95
    v_fmac_f32 v124, v18, v23
    v_fmac_f32 v124, v95, v28
    v_lshlrev_b32 v18, 16, v96
    v_and_b32 v96, 0xffff0000, v96
    v_fmac_f32 v124, v18, v24
    v_fmac_f32 v124, v96, v29
    v_mov_b32 v125, 0
    v_lshlrev_b32 v18, 16, v97
    v_and_b32 v97, 0xffff0000, v97
    v_fmac_f32 v125, v18, v20
    v_fmac_f32 v125, v97, v25
    v_lshlrev_b32 v18, 16, v98
    v_and_b32 v98, 0xffff0000, v98
    v_fmac_f32 v125, v18, v21
    v_fmac_f32 v125, v98, v26
    v_lshlrev_b32 v18, 16, v99
    v_and_b32 v99, 0xffff0000, v99
    v_fmac_f32 v125, v18, v22
    v_fmac_f32 v125, v99, v27
    v_lshlrev_b32 v18, 16, v100
    v_and_b32 v100, 0xffff0000, v100
    v_fmac_f32 v125, v18, v23
    v_fmac_f32 v125, v100, v28
    v_lshlrev_b32 v18, 16, v101
    v_and_b32 v101, 0xffff0000, v101
    v_fmac_f32 v125, v18, v24
    v_fmac_f32 v125, v101, v29
    v_mov_b32 v126, 0
    v_lshlrev_b32 v18, 16, v102
    v_and_b32 v102, 0xffff0000, v102
    v_fmac_f32 v126, v18, v20
    v_fmac_f32 v126, v102, v25
    v_lshlrev_b32 v18, 16, v103
    v_and_b32 v103, 0xffff0000, v103
    v_fmac_f32 v126, v18, v21
    v_fmac_f32 v126, v103, v26
    v_lshlrev_b32 v18, 16, v104
    v_and_b32 v104, 0xffff0000, v104
    v_fmac_f32 v126, v18, v22
    v_fmac_f32 v126, v104, v27
    v_lshlrev_b32 v18, 16, v105
    v_and_b32 v105, 0xffff0000, v105
    v_fmac_f32 v126, v18, v23
    v_fmac_f32 v126, v105, v28
    v_lshlrev_b32 v18, 16, v106
    v_and_b32 v106, 0xffff0000, v106
    v_fmac_f32 v126, v18, v24
    v_fmac_f32 v126, v106, v29
    v_mov_b32 v127, 0
    v_lshlrev_b32 v18, 16, v107
    v_and_b32 v107, 0xffff0000, v107
    v_fmac_f32 v127, v18, v20
    v_fmac_f32 v127, v107, v25
    v_lshlrev_b32 v18, 16, v108
    v_and_b32 v108, 0xffff0000, v108
    v_fmac_f32 v127, v18, v21
    v_fmac_f32 v127, v108, v26
    v_lshlrev_b32 v18, 16, v109
    v_and_b32 v109, 0xffff0000, v109
    v_fmac_f32 v127, v18, v22
    v_fmac_f32 v127, v109, v27
    v_lshlrev_b32 v18, 16, v110
    v_and_b32 v110, 0xffff0000, v110
    v_fmac_f32 v127, v18, v23
    v_fmac_f32 v127, v110, v28
    v_lshlrev_b32 v18, 16, v111
    v_and_b32 v111, 0xffff0000, v111
    v_fmac_f32 v127, v18, v24
    v_fmac_f32 v127, v111, v29
    s_nop 1
    v_add_f32_dpp v112, v112, v112 row_ror:8 row_mask:0xf bank_mask:0xf
    v_add_f32_dpp v113, v113, v113 row_ror:8 row_mask:0xf bank_mask:0xf
    v_add_f32_dpp v114, v114, v114 row_ror:8 row_mask:0xf bank_mask:0xf
    v_add_f32_dpp v115, v115, v115 row_ror:8 row_mask:0xf bank_mask:0xf
    v_add_f32_dpp v116, v116, v116 row_ror:8 row_mask:0xf bank_mask:0xf
    v_add_f32_dpp v117, v117, v117 row_ror:8 row_mask:0xf bank_mask:0xf
    v_add_f32_dpp v118, v118, v118 row_ror:8 row_mask:0xf bank_mask:0xf
    v_add_f32_dpp v119, v119, v119 row_ror:8 row_mask:0xf bank_mask:0xf
    v_add_f32_dpp v120, v120, v120 row_ror:8 row_mask:0xf bank_mask:0xf
    v_add_f32_dpp v121, v121, v121 row_ror:8 row_mask:0xf bank_mask:0xf
    v_add_f32_dpp v122, v122, v122 row_ror:8 row_mask:0xf bank_mask:0xf
    v_add_f32_dpp v123, v123, v123 row_ror:8 row_mask:0xf bank_mask:0xf
    v_add_f32_dpp v124, v124, v124 row_ror:8 row_mask:0xf bank_mask:0xf
    v_add_f32_dpp v125, v125, v125 row_ror:8 row_mask:0xf bank_mask:0xf
    v_add_f32_dpp v126, v126, v126 row_ror:8 row_mask:0xf bank_mask:0xf
    v_add_f32_dpp v127, v127, v127 row_ror:8 row_mask:0xf bank_mask:0xf
    s_nop 1
    v_add_f32_dpp v112, v112, v112 row_ror:4 row_mask:0xf bank_mask:0xf
    v_add_f32_dpp v113, v113, v113 row_ror:4 row_mask:0xf bank_mask:0xf
    v_add_f32_dpp v114, v114, v114 row_ror:4 row_mask:0xf bank_mask:0xf
    v_add_f32_dpp v115, v115, v115 row_ror:4 row_mask:0xf bank_mask:0xf
    v_add_f32_dpp v116, v116, v116 row_ror:4 row_mask:0xf bank_mask:0xf
    v_add_f32_dpp v117, v117, v117 row_ror:4 row_mask:0xf bank_mask:0xf
    v_add_f32_dpp v118, v118, v118 row_ror:4 row_mask:0xf bank_mask:0xf
    v_add_f32_dpp v119, v119, v119 row_ror:4 row_mask:0xf bank_mask:0xf
    v_add_f32_dpp v120, v120, v120 row_ror:4 row_mask:0xf bank_mask:0xf
    v_add_f32_dpp v121, v121, v121 row_ror:4 row_mask:0xf bank_mask:0xf
    v_add_f32_dpp v122, v122, v122 row_ror:4 row_mask:0xf bank_mask:0xf
    v_add_f32_dpp v123, v123, v123 row_ror:4 row_mask:0xf bank_mask:0xf
    v_add_f32_dpp v124, v124, v124 row_ror:4 row_mask:0xf bank_mask:0xf
    v_add_f32_dpp v125, v125, v125 row_ror:4 row_mask:0xf bank_mask:0xf
    v_add_f32_dpp v126, v126, v126 row_ror:4 row_mask:0xf bank_mask:0xf
    v_add_f32_dpp v127, v127, v127 row_ror:4 row_mask:0xf bank_mask:0xf
    s_nop 1
    v_add_f32_dpp v112, v112, v112 row_ror:2 row_mask:0xf bank_mask:0xf
    v_add_f32_dpp v113, v113, v113 row_ror:2 row_mask:0xf bank_mask:0xf
    v_add_f32_dpp v114, v114, v114 row_ror:2 row_mask:0xf bank_mask:0xf
    v_add_f32_dpp v115, v115, v115 row_ror:2 row_mask:0xf bank_mask:0xf
    v_add_f32_dpp v116, v116, v116 row_ror:2 row_mask:0xf bank_mask:0xf
    v_add_f32_dpp v117, v117, v117 row_ror:2 row_mask:0xf bank_mask:0xf
    v_add_f32_dpp v118, v118, v118 row_ror:2 row_mask:0xf bank_mask:0xf
    v_add_f32_dpp v119, v119, v119 row_ror:2 row_mask:0xf bank_mask:0xf
    v_add_f32_dpp v120, v120, v120 row_ror:2 row_mask:0xf bank_mask:0xf
    v_add_f32_dpp v121, v121, v121 row_ror:2 row_mask:0xf bank_mask:0xf
    v_add_f32_dpp v122, v122, v122 row_ror:2 row_mask:0xf bank_mask:0xf
    v_add_f32_dpp v123, v123, v123 row_ror:2 row_mask:0xf bank_mask:0xf
    v_add_f32_dpp v124, v124, v124 row_ror:2 row_mask:0xf bank_mask:0xf
    v_add_f32_dpp v125, v125, v125 row_ror:2 row_mask:0xf bank_mask:0xf
    v_add_f32_dpp v126, v126, v126 row_ror:2 row_mask:0xf bank_mask:0xf
    v_add_f32_dpp v127, v127, v127 row_ror:2 row_mask:0xf bank_mask:0xf
    s_nop 1
    v_add_f32_dpp v112, v112, v112 row_ror:1 row_mask:0xf bank_mask:0xf
    v_add_f32_dpp v113, v113, v113 row_ror:1 row_mask:0xf bank_mask:0xf
    v_add_f32_dpp v114, v114, v114 row_ror:1 row_mask:0xf bank_mask:0xf
    v_add_f32_dpp v115, v115, v115 row_ror:1 row_mask:0xf bank_mask:0xf
    v_add_f32_dpp v116, v116, v116 row_ror:1 row_mask:0xf bank_mask:0xf
    v_add_f32_dpp v117, v117, v117 row_ror:1 row_mask:0xf bank_mask:0xf
    v_add_f32_dpp v118, v118, v118 row_ror:1 row_mask:0xf bank_mask:0xf
    v_add_f32_dpp v119, v119, v119 row_ror:1 row_mask:0xf bank_mask:0xf
    v_add_f32_dpp v120, v120, v120 row_ror:1 row_mask:0xf bank_mask:0xf
    v_add_f32_dpp v121, v121, v121 row_ror:1 row_mask:0xf bank_mask:0xf
    v_add_f32_dpp v122, v122, v122 row_ror:1 row_mask:0xf bank_mask:0xf
    v_add_f32_dpp v123, v123, v123 row_ror:1 row_mask:0xf bank_mask:0xf
    v_add_f32_dpp v124, v124, v124 row_ror:1 row_mask:0xf bank_mask:0xf
    v_add_f32_dpp v125, v125, v125 row_ror:1 row_mask:0xf bank_mask:0xf
    v_add_f32_dpp v126, v126, v126 row_ror:1 row_mask:0xf bank_mask:0xf
    v_add_f32_dpp v127, v127, v127 row_ror:1 row_mask:0xf bank_mask:0xf
    v_mov_b32 v128, v112
    v_mov_b32 v129, v113
    v_mov_b32 v130, v114
    v_mov_b32 v131, v115
    v_mov_b32 v132, v116
    v_mov_b32 v133, v117
    v_mov_b32 v134, v118
    v_mov_b32 v135, v119
    v_mov_b32 v136, v120
    v_mov_b32 v137, v121
    v_mov_b32 v138, v122
    v_mov_b32 v139, v123
    v_mov_b32 v140, v124
    v_mov_b32 v141, v125
    v_mov_b32 v142, v126
    v_mov_b32 v143, v127
    s_nop 1
    v_permlane32_swap_b32 v112, v128
    v_permlane32_swap_b32 v113, v129
    v_permlane32_swap_b32 v114, v130
    v_permlane32_swap_b32 v115, v131
    v_permlane32_swap_b32 v116, v132
    v_permlane32_swap_b32 v117, v133
    v_permlane32_swap_b32 v118, v134
    v_permlane32_swap_b32 v119, v135
    v_permlane32_swap_b32 v120, v136
    v_permlane32_swap_b32 v121, v137
    v_permlane32_swap_b32 v122, v138
    v_permlane32_swap_b32 v123, v139
    v_permlane32_swap_b32 v124, v140
    v_permlane32_swap_b32 v125, v141
    v_permlane32_swap_b32 v126, v142
    v_permlane32_swap_b32 v127, v143
    s_nop 1
    v_add_f32 v112, v112, v128
    v_mov_b32 v128, v112
    v_add_f32 v113, v113, v129
    v_mov_b32 v129, v113
    v_add_f32 v114, v114, v130
    v_mov_b32 v130, v114
    v_add_f32 v115, v115, v131
    v_mov_b32 v131, v115
    v_add_f32 v116, v116, v132
    v_mov_b32 v132, v116
    v_add_f32 v117, v117, v133
    v_mov_b32 v133, v117
    v_add_f32 v118, v118, v134
    v_mov_b32 v134, v118
    v_add_f32 v119, v119, v135
    v_mov_b32 v135, v119
    v_add_f32 v120, v120, v136
    v_mov_b32 v136, v120
    v_add_f32 v121, v121, v137
    v_mov_b32 v137, v121
    v_add_f32 v122, v122, v138
    v_mov_b32 v138, v122
    v_add_f32 v123, v123, v139
    v_mov_b32 v139, v123
    v_add_f32 v124, v124, v140
    v_mov_b32 v140, v124
    v_add_f32 v125, v125, v141
    v_mov_b32 v141, v125
    v_add_f32 v126, v126, v142
    v_mov_b32 v142, v126
    v_add_f32 v127, v127, v143
    v_mov_b32 v143, v127
    s_nop 1
    v_permlane16_swap_b32 v112, v128
    v_permlane16_swap_b32 v113, v129
    v_permlane16_swap_b32 v114, v130
    v_permlane16_swap_b32 v115, v131
    v_permlane16_swap_b32 v116, v132
    v_permlane16_swap_b32 v117, v133
    v_permlane16_swap_b32 v118, v134
    v_permlane16_swap_b32 v119, v135
    v_permlane16_swap_b32 v120, v136
    v_permlane16_swap_b32 v121, v137
    v_permlane16_swap_b32 v122, v138
    v_permlane16_swap_b32 v123, v139
    v_permlane16_swap_b32 v124, v140
    v_permlane16_swap_b32 v125, v141
    v_permlane16_swap_b32 v126, v142
    v_permlane16_swap_b32 v127, v143
    s_nop 1
    v_add_f32 v112, v112, v128
    v_add_f32 v113, v113, v129
    v_add_f32 v114, v114, v130
    v_add_f32 v115, v115, v131
    v_add_f32 v116, v116, v132
    v_add_f32 v117, v117, v133
    v_add_f32 v118, v118, v134
    v_add_f32 v119, v119, v135
    v_add_f32 v120, v120, v136
    v_add_f32 v121, v121, v137
    v_add_f32 v122, v122, v138
    v_add_f32 v123, v123, v139
    v_add_f32 v124, v124, v140
    v_add_f32 v125, v125, v141
    v_add_f32 v126, v126, v142
    v_add_f32 v127, v127, v143
    v_and_b32 v18, 15, v1
    v_mov_b32 v19, v112
    v_cmp_eq_u32 vcc, 1, v18
    s_nop 1
    v_cndmask_b32 v19, v19, v113, vcc
    v_cmp_eq_u32 vcc, 2, v18
    s_nop 1
    v_cndmask_b32 v19, v19, v114, vcc
    v_cmp_eq_u32 vcc, 3, v18
    s_nop 1
    v_cndmask_b32 v19, v19, v115, vcc
    v_cmp_eq_u32 vcc, 4, v18
    s_nop 1
    v_cndmask_b32 v19, v19, v116, vcc
    v_cmp_eq_u32 vcc, 5, v18
    s_nop 1
    v_cndmask_b32 v19, v19, v117, vcc
    v_cmp_eq_u32 vcc, 6, v18
    s_nop 1
    v_cndmask_b32 v19, v19, v118, vcc
    v_cmp_eq_u32 vcc, 7, v18
    s_nop 1
    v_cndmask_b32 v19, v19, v119, vcc
    v_cmp_eq_u32 vcc, 8, v18
    s_nop 1
    v_cndmask_b32 v19, v19, v120, vcc
    v_cmp_eq_u32 vcc, 9, v18
    s_nop 1
    v_cndmask_b32 v19, v19, v121, vcc
    v_cmp_eq_u32 vcc, 10, v18
    s_nop 1
    v_cndmask_b32 v19, v19, v122, vcc
    v_cmp_eq_u32 vcc, 11, v18
    s_nop 1
    v_cndmask_b32 v19, v19, v123, vcc
    v_cmp_eq_u32 vcc, 12, v18
    s_nop 1
    v_cndmask_b32 v19, v19, v124, vcc
    v_cmp_eq_u32 vcc, 13, v18
    s_nop 1
    v_cndmask_b32 v19, v19, v125, vcc
    v_cmp_eq_u32 vcc, 14, v18
    s_nop 1
    v_cndmask_b32 v19, v19, v126, vcc
    v_cmp_eq_u32 vcc, 15, v18
    s_nop 1
    v_cndmask_b32 v19, v19, v127, vcc
    v_mul_f32 v19, 0xbfb8aa3b, v19
    v_exp_f32 v19, v19
    s_nop 0
    v_add_f32 v19, 1.0, v19
    v_rcp_f32 v19, v19
    s_lshl_b32 s46, s35, 2
    s_add_u32 s46, s46, 15728640
    v_lshlrev_b32 v18, 2, v18
    s_mov_b64 exec, 0xffff
    buffer_store_dword v19, v18, s[20:23], s46 offen
    s_branch K1_END
K1_FIN:
K1_END:
    s_endpgm
K1_TEXT_END:
.globl k2_attn_kernel
.p2align 8
.type k2_attn_kernel,@function
k2_attn_kernel:
    s_cmp_ge_u32 s2, 256
    s_cbranch_scc1 K2_END
    s_load_dwordx2 s[4:5], s[0:1], 72
    s_load_dwordx2 s[60:61], s[0:1], 56
    v_and_b32 v1, 63, v0
    v_lshrrev_b32 v8, 6, v0
    s_and_b32 s13, s2, 7
    v_readfirstlane_b32 s12, v8
    s_lshl_b32 s13, s13, 2
    s_lshr_b32 s16, s2, 6
    s_add_u32 s13, s13, s16
    s_lshr_b32 s14, s2, 3
    s_and_b32 s14, s14, 7
    v_lshlrev_b32 v2, 4, v1
    v_and_b32 v8, 31, v1
    v_lshlrev_b32 v3, 3, v8
    v_lshrrev_b32 v9, 5, v1
    v_lshl_add_u32 v23, v9, 8, v3
    s_lshr_b32 s26, s12, 2
    s_and_b32 s27, s12, 3
    s_mul_i32 s28, s13, 163840
    s_add_u32 s28, s28, 5242880
    s_add_u32 s16, s12, 0
    s_lshl_b32 s44, s16, 10
    s_cmp_ge_u32 s16, 20
    s_cselect_b32 s17, 61440, 0
    s_add_u32 s44, s44, s17
    s_add_u32 s16, s12, 8
    s_lshl_b32 s45, s16, 10
    s_cmp_ge_u32 s16, 20
    s_cselect_b32 s17, 61440, 0
    s_add_u32 s45, s45, s17
    s_add_u32 s16, s12, 16
    s_lshl_b32 s46, s16, 10
    s_cmp_ge_u32 s16, 20
    s_cselect_b32 s17, 61440, 0
    s_add_u32 s46, s46, s17
    s_add_u32 s16, s12, 24
    s_lshl_b32 s47, s16, 10
    s_cmp_ge_u32 s16, 20
    s_cselect_b32 s17, 61440, 0
    s_add_u32 s47, s47, s17
    s_add_u32 s16, s12, 32
    s_lshl_b32 s48, s16, 10
    s_cmp_ge_u32 s16, 20
    s_cselect_b32 s17, 61440, 0
    s_add_u32 s48, s48, s17
    s_mul_i32 s33, s13, 81920
    s_lshl_b32 s17, s14, 3
    s_lshl_b32 s18, s27, 1
    s_add_u32 s17, s17, s18
    s_mul_i32 s17, s17, 1280
    s_add_u32 s33, s33, s17
    s_add_u32 s16, s33, 13107200
    s_mov_b32 s29, 0
    s_waitcnt lgkmcnt(0)
    s_mov_b32 s8, s4
    s_and_b32 s9, s5, 0xffff
    s_mov_b32 s10, 37748736
    s_mov_b32 s11, 0x00020000
    s_add_u32 m0, s44, s29
    s_add_u32 s19, m0, s28
    buffer_load_dwordx4 v2, s[8:11], s19 offen lds
    s_add_u32 m0, s45, s29
    s_add_u32 s19, m0, s28
    buffer_load_dwordx4 v2, s[8:11], s19 offen lds
    s_add_u32 m0, s46, s29
    s_add_u32 s19, m0, s28
    buffer_load_dwordx4 v2, s[8:11], s19 offen lds
    s_add_u32 m0, s47, s29
    s_add_u32 s19, m0, s28
    buffer_load_dwordx4 v2, s[8:11], s19 offen lds
    s_add_u32 m0, s48, s29
    s_add_u32 s19, m0, s28
    buffer_load_dwordx4 v2, s[8:11], s19 offen lds
    buffer_load_dwordx2 v[24:25], v23, s[8:11], s16 offen offset:0
    buffer_load_dwordx2 v[26:27], v23, s[8:11], s16 offen offset:512
    buffer_load_dwordx2 v[32:33], v3, s[8:11], s16 offen offset:1024
    buffer_load_dwordx2 v[28:29], v23, s[8:11], s16 offen offset:1280
    buffer_load_dwordx2 v[30:31], v23, s[8:11], s16 offen offset:1792
    buffer_load_dwordx2 v[34:35], v3, s[8:11], s16 offen offset:2304
    s_add_u32 s29, s29, 20480
    s_mov_b32 s22, 0x000fffff
    s_mov_b32 s23, 0x000fffff
    s_mov_b32 s24, -1
    s_mov_b32 s25, 0
    v_and_b32 v8, 31, v1
    v_lshrrev_b32 v9, 5, v1
    v_mul_u32_u24 v4, 20, v9
    v_add_u32 v4, v4, v8
    v_lshlrev_b32 v4, 4, v4
    v_mov_b64 v[148:149], 0
    v_mov_b64 v[150:151], 0
    v_mov_b64 v[152:153], 0
    v_mov_b64 v[154:155], 0
    v_mov_b64 v[156:157], 0
    v_mov_b64 v[158:159], 0
    v_mov_b64 v[160:161], 0
    v_mov_b64 v[162:163], 0
    v_mov_b64 v[164:165], 0
    v_mov_b64 v[166:167], 0
    v_mov_b64 v[168:169], 0
    v_mov_b64 v[170:171], 0
    v_mov_b64 v[172:173], 0
    v_mov_b64 v[174:175], 0
    v_mov_b64 v[176:177], 0
    v_mov_b64 v[178:179], 0
    v_mov_b64 v[76:77], 0
    v_mov_b64 v[78:79], 0
    s_lshl_b32 s15, s14, 8
    s_lshl_b32 s16, s27, 6
    s_add_u32 s15, s15, s16
    s_lshl_b32 s16, s26, 5
    s_add_u32 s15, s15, s16
    s_mul_i32 s16, s26, 1280
    s_add_u32 s33, s33, s16
    s_add_u32 s33, s33, 10485760
    s_lshl_b32 s16, s13, 6
    s_lshr_b32 s17, s15, 5
    s_add_u32 s16, s16, s17
    s_add_i32 s17, s16, -1
    s_ashr_i32 s18, s17, 3
    s_mul_i32 s18, s18, 20480
    s_and_b32 s17, s17, 7
    s_mul_i32 s17, s17, 1280
    s_add_u32 s50, s17, s18
    s_add_i32 s17, s16, 0
    s_ashr_i32 s18, s17, 3
    s_mul_i32 s18, s18, 20480
    s_and_b32 s17, s17, 7
    s_mul_i32 s17, s17, 1280
    s_add_u32 s51, s17, s18
    s_add_i32 s17, s16, 1
    s_ashr_i32 s18, s17, 3
    s_mul_i32 s18, s18, 20480
    s_and_b32 s17, s17, 7
    s_mul_i32 s17, s17, 1280
    s_add_u32 s52, s17, s18
    s_add_u32 s50, s50, 128
    s_sub_u32 s53, s51, 128
    s_add_u32 s51, s51, 128
    s_sub_u32 s52, s52, 128
    s_mov_b32 s54, 0xffff
    s_mov_b32 s55, 0xffff
    v_add_u32 v19, s53, v3
    v_add_u32 v21, s52, v3
    s_mov_b64 exec, s[54:55]
    v_add_u32 v19, s50, v3
    v_add_u32 v21, s51, v3
    s_mov_b64 exec, -1
    v_sub_u32 v15, v23, v3
    v_add_u32 v18, v19, v15
    v_add_u32 v20, v21, v15
    s_lshl_b32 s16, s13, 7
    s_lshr_b32 s17, s15, 4
    s_add_u32 s16, s16, s17
    s_add_i32 s17, s16, -1
    s_max_i32 s17, s17, 0
    s_lshr_b32 s18, s17, 4
    s_mul_i32 s18, s18, 20480
    s_and_b32 s17, s17, 15
    s_mul_i32 s17, s17, 640
    s_add_u32 s17, s17, s18
    s_add_u32 s30, s17, 10240
    s_add_i32 s17, s16, 0
    s_max_i32 s17, s17, 0
    s_lshr_b32 s18, s17, 4
    s_mul_i32 s18, s18, 20480
    s_and_b32 s17, s17, 15
    s_mul_i32 s17, s17, 640
    s_add_u32 s17, s17, s18
    s_add_u32 s31, s17, 10240
    s_add_i32 s17, s16, 1
    s_max_i32 s17, s17, 0
    s_lshr_b32 s18, s17, 4
    s_mul_i32 s18, s18, 20480
    s_and_b32 s17, s17, 15
    s_mul_i32 s17, s17, 640
    s_add_u32 s17, s17, s18
    s_add_u32 s32, s17, 10240
    s_lshl_b32 s35, s15, 2
    s_add_u32 s35, s35, 15728640
    v_mov_b32 v10, 0
    v_mov_b32 v11, 0x3f803f80
    v_cmp_eq_u32 vcc, 20, v8
    v_cmp_eq_u32 s[38:39], 24, v8
    s_nop 1
    s_or_b64 vcc, vcc, s[38:39]
    s_nop 1
    v_cndmask_b32 v10, v10, v11, vcc
    v_mov_b32 v11, v10
    v_mov_b64 v[192:193], v[10:11]
    v_mov_b64 v[194:195], v[10:11]
    v_mov_b64 v[196:197], v[10:11]
    v_mov_b64 v[198:199], v[10:11]
    v_mov_b64 v[200:201], v[10:11]
    v_mov_b64 v[202:203], v[10:11]
    v_mov_b64 v[56:57], v[10:11]
    v_mov_b64 v[58:59], v[10:11]
    v_mov_b64 v[60:61], v[10:11]
    v_mov_b64 v[62:63], v[10:11]
    v_mov_b64 v[64:65], v[10:11]
    v_mov_b64 v[66:67], v[10:11]
    v_mov_b64 v[68:69], v[10:11]
    v_mov_b64 v[70:71], v[10:11]
    s_lshr_b32 s16, s15, 4
    s_mul_i32 s16, s16, 40960
    s_mul_i32 s17, s13, 1280
    s_add_u32 s16, s16, s17
    v_bfe_u32 v10, v1, 4, 1
    v_mul_u32_u24 v10, 40960, v10
    v_and_b32 v11, 15, v1
    v_lshl_add_u32 v11, v11, 4, v10
    v_lshrrev_b32 v10, 5, v1
    v_lshl_add_u32 v11, v10, 8, v11
    v_add_u32 v245, s16, v11
    s_getpc_b64 s[56:57]
K2_PC:
    s_add_u32 s56, s56, K2_TABLE-K2_PC
    s_addc_u32 s57, s57, 0
    s_mov_b32 s64, s13
    s_mov_b32 s65, s14
    s_mul_i32 s59, s65, 204800
    s_lshl_b32 s16, s12, 10
    s_add_u32 s59, s59, s16
    s_add_u32 s59, s59, 15794176
    s_mov_b32 s58, s59
    s_mov_b32 s49, 0
    s_mov_b32 s66, 2
    s_mov_b32 s21, 0
    s_mul_i32 s37, s26, 81920
    s_waitcnt vmcnt(0)
    s_mov_b64 exec, s[24:25]
    s_not_b64 exec, exec
    v_mov_b32 v32, 0
    v_mov_b32 v33, 0
    v_mov_b32 v34, 0
    v_mov_b32 v35, 0
    s_mov_b64 exec, -1
    s_barrier
K2_START:
    v_add_u32 v5, s37, v23
    v_add_u32 v6, 1280, v5
    v_add_u32 v7, s37, v3
    v_add_u32 v17, s37, v4
    v_add_u32 v17, 10240, v17
    ds_read2st64_b64 v[44:47], v5 offset0:0 offset1:1
    ds_read_b64 v[52:53], v7 offset:1024
    s_mov_b64 exec, s[22:23]
    ds_read_b128 v[56:59], v17
    s_mov_b64 exec, -1
    s_cmp_lg_u32 s21, 0
    s_cbranch_scc1 K2_HAVEM
    s_waitcnt lgkmcnt(0)
    v_mfma_f32_32x32x16_bf16 v[84:99], v[44:47], v[24:27], 0
    v_mfma_f32_32x32x8_bf16 v[84:99], v[52:53], v[32:33], v[84:99]
    v_mfma_f32_32x32x16_bf16 v[100:115], v[44:47], v[28:31], 0
    v_mfma_f32_32x32x8_bf16 v[100:115], v[52:53], v[34:35], v[100:115]
    s_nop 9
    v_max3_f32 v8, v84, v85, v86
    v_max3_f32 v8, v8, v87, v88
    v_max3_f32 v8, v8, v89, v90
    v_max3_f32 v8, v8, v91, v92
    v_max3_f32 v8, v8, v93, v94
    v_max3_f32 v8, v8, v95, v96
    v_max3_f32 v8, v8, v97, v98
    v_max_f32 v8, v8, v99
    v_mov_b32 v9, v8
    v_max3_f32 v10, v100, v101, v102
    v_max3_f32 v10, v10, v103, v104
    v_max3_f32 v10, v10, v105, v106
    v_max3_f32 v10, v10, v107, v108
    v_max3_f32 v10, v10, v109, v110
    v_max3_f32 v10, v10, v111, v112
    v_max3_f32 v10, v10, v113, v114
    v_max_f32 v10, v10, v115
    v_mov_b32 v11, v10
    s_nop 1
    v_permlane32_swap_b32 v8, v9
    v_permlane32_swap_b32 v10, v11
    s_nop 1
    v_max_f32 v8, v8, v9
    v_sub_f32 v116, 0, v8
    v_sub_f32 v117, 0, v8
    v_mov_b64 v[118:119], v[116:117]
    v_mov_b64 v[120:121], v[116:117]
    v_mov_b64 v[122:123], v[116:117]
    v_mov_b64 v[124:125], v[116:117]
    v_mov_b64 v[126:127], v[116:117]
    v_mov_b64 v[128:129], v[116:117]
    v_mov_b64 v[130:131], v[116:117]
    v_max_f32 v10, v10, v11
    v_sub_f32 v132, 0, v10
    v_sub_f32 v133, 0, v10
    v_mov_b64 v[134:135], v[132:133]
    v_mov_b64 v[136:137], v[132:133]
    v_mov_b64 v[138:139], v[132:133]
    v_mov_b64 v[140:141], v[132:133]
    v_mov_b64 v[142:143], v[132:133]
    v_mov_b64 v[144:145], v[132:133]
    v_mov_b64 v[146:147], v[132:133]
    v_pk_add_f32 v[84:85], v[84:85], v[116:117]
    v_pk_add_f32 v[86:87], v[86:87], v[116:117]
    v_pk_add_f32 v[88:89], v[88:89], v[116:117]
    v_pk_add_f32 v[90:91], v[90:91], v[116:117]
    v_pk_add_f32 v[92:93], v[92:93], v[116:117]
    v_pk_add_f32 v[94:95], v[94:95], v[116:117]
    v_pk_add_f32 v[96:97], v[96:97], v[116:117]
    v_pk_add_f32 v[98:99], v[98:99], v[116:117]
    s_mov_b32 s20, 0
    s_branch K2_GO
K2_HAVEM:
    s_waitcnt lgkmcnt(0)
    s_nop 1
    v_mfma_f32_32x32x16_bf16 v[84:99], v[44:47], v[24:27], v[116:131]
    v_mfma_f32_32x32x8_bf16 v[84:99], v[52:53], v[32:33], v[84:99]
    s_mov_b32 s20, 0
    s_nop 15
K2_GO:
    s_cmp_lg_u32 s21, 0
    s_cbranch_scc1 K2_RLOOP
    v_mfma_f32_32x32x16_bf16 v[100:115], v[44:47], v[28:31], v[132:147]
    ds_read2st64_b64 v[48:51], v6 offset0:0 offset1:1
    ds_read_b64 v[54:55], v7 offset:2304
    v_exp_f32 v84, v84
    v_exp_f32 v85, v85
    v_exp_f32 v86, v86
    v_exp_f32 v87, v87
    v_mfma_f32_32x32x16_bf16 v[164:179], v[68:71], v[76:79], v[164:179]
    s_mov_b64 exec, s[22:23]
    ds_read_b128 v[64:67], v17 offset:640
    ds_read_b128 v[60:63], v17 offset:1280
    s_mov_b64 exec, -1
    v_exp_f32 v88, v88
    v_exp_f32 v89, v89
    v_exp_f32 v90, v90
    v_exp_f32 v91, v91
    v_cvt_pk_bf16_f32 v72, v84, v85
    v_cvt_pk_bf16_f32 v73, v86, v87
    v_cvt_pk_bf16_f32 v74, v88, v89
    v_cvt_pk_bf16_f32 v75, v90, v91
    v_mfma_f32_32x32x8_bf16 v[100:115], v[52:53], v[34:35], v[100:115]
    v_exp_f32 v92, v92
    v_exp_f32 v93, v93
    v_exp_f32 v94, v94
    v_exp_f32 v95, v95
    v_mfma_f32_32x32x16_bf16 v[148:163], v[56:59], v[72:75], v[148:163]
    v_exp_f32 v96, v96
    v_exp_f32 v97, v97
    v_exp_f32 v98, v98
    v_exp_f32 v99, v99
    v_cvt_pk_bf16_f32 v76, v92, v93
    v_cvt_pk_bf16_f32 v77, v94, v95
    v_cvt_pk_bf16_f32 v78, v96, v97
    v_cvt_pk_bf16_f32 v79, v98, v99
    s_waitcnt lgkmcnt(0)
    v_mfma_f32_32x32x16_bf16 v[84:99], v[48:51], v[24:27], v[116:131]
    v_exp_f32 v100, v100
    v_exp_f32 v101, v101
    v_exp_f32 v102, v102
    v_exp_f32 v103, v103
    v_mfma_f32_32x32x16_bf16 v[148:163], v[64:67], v[76:79], v[148:163]
    s_add_u32 m0, s44, s29
    s_add_u32 s19, m0, s28
    buffer_load_dwordx4 v2, s[8:11], s19 offen lds
    v_exp_f32 v104, v104
    v_exp_f32 v105, v105
    v_exp_f32 v106, v106
    v_exp_f32 v107, v107
    v_cvt_pk_bf16_f32 v72, v100, v101
    v_cvt_pk_bf16_f32 v73, v102, v103
    v_cvt_pk_bf16_f32 v74, v104, v105
    v_cvt_pk_bf16_f32 v75, v106, v107
    v_mfma_f32_32x32x8_bf16 v[84:99], v[54:55], v[32:33], v[84:99]
    v_exp_f32 v108, v108
    v_exp_f32 v109, v109
    v_exp_f32 v110, v110
    v_exp_f32 v111, v111
    v_mfma_f32_32x32x16_bf16 v[164:179], v[56:59], v[72:75], v[164:179]
    v_exp_f32 v112, v112
    v_exp_f32 v113, v113
    v_exp_f32 v114, v114
    v_exp_f32 v115, v115
    v_cvt_pk_bf16_f32 v76, v108, v109
    v_cvt_pk_bf16_f32 v77, v110, v111
    v_cvt_pk_bf16_f32 v78, v112, v113
    v_cvt_pk_bf16_f32 v79, v114, v115
    v_mfma_f32_32x32x16_bf16 v[100:115], v[48:51], v[28:31], v[132:147]
    ds_read2st64_b64 v[44:47], v5 offset0:5 offset1:6
    ds_read_b64 v[52:53], v7 offset:3584
    v_exp_f32 v84, v84
    v_exp_f32 v85, v85
    v_exp_f32 v86, v86
    v_exp_f32 v87, v87
    v_mfma_f32_32x32x16_bf16 v[164:179], v[64:67], v[76:79], v[164:179]
    s_mov_b64 exec, s[22:23]
    ds_read_b128 v[68:71], v17 offset:1920
    ds_read_b128 v[56:59], v17 offset:2560
    s_mov_b64 exec, -1
    v_exp_f32 v88, v88
    v_exp_f32 v89, v89
    v_exp_f32 v90, v90
    v_exp_f32 v91, v91
    v_cvt_pk_bf16_f32 v72, v84, v85
    v_cvt_pk_bf16_f32 v73, v86, v87
    v_cvt_pk_bf16_f32 v74, v88, v89
    v_cvt_pk_bf16_f32 v75, v90, v91
    v_mfma_f32_32x32x8_bf16 v[100:115], v[54:55], v[34:35], v[100:115]
    v_exp_f32 v92, v92
    v_exp_f32 v93, v93
    v_exp_f32 v94, v94
    v_exp_f32 v95, v95
    v_mfma_f32_32x32x16_bf16 v[148:163], v[60:63], v[72:75], v[148:163]
    v_exp_f32 v96, v96
    v_exp_f32 v97, v97
    v_exp_f32 v98, v98
    v_exp_f32 v99, v99
    v_cvt_pk_bf16_f32 v76, v92, v93
    v_cvt_pk_bf16_f32 v77, v94, v95
    v_cvt_pk_bf16_f32 v78, v96, v97
    v_cvt_pk_bf16_f32 v79, v98, v99
    s_waitcnt lgkmcnt(0)
    v_mfma_f32_32x32x16_bf16 v[84:99], v[44:47], v[24:27], v[116:131]
    v_exp_f32 v100, v100
    v_exp_f32 v101, v101
    v_exp_f32 v102, v102
    v_exp_f32 v103, v103
    v_mfma_f32_32x32x16_bf16 v[148:163], v[68:71], v[76:79], v[148:163]
    s_add_u32 m0, s45, s29
    s_add_u32 s19, m0, s28
    buffer_load_dwordx4 v2, s[8:11], s19 offen lds
    v_exp_f32 v104, v104
    v_exp_f32 v105, v105
    v_exp_f32 v106, v106
    v_exp_f32 v107, v107
    v_cvt_pk_bf16_f32 v72, v100, v101
    v_cvt_pk_bf16_f32 v73, v102, v103
    v_cvt_pk_bf16_f32 v74, v104, v105
    v_cvt_pk_bf16_f32 v75, v106, v107
    v_mfma_f32_32x32x8_bf16 v[84:99], v[52:53], v[32:33], v[84:99]
    v_exp_f32 v108, v108
    v_exp_f32 v109, v109
    v_exp_f32 v110, v110
    v_exp_f32 v111, v111
    v_mfma_f32_32x32x16_bf16 v[164:179], v[60:63], v[72:75], v[164:179]
    v_exp_f32 v112, v112
    v_exp_f32 v113, v113
    v_exp_f32 v114, v114
    v_exp_f32 v115, v115
    v_cvt_pk_bf16_f32 v76, v108, v109
    v_cvt_pk_bf16_f32 v77, v110, v111
    v_cvt_pk_bf16_f32 v78, v112, v113
    v_cvt_pk_bf16_f32 v79, v114, v115
    v_mfma_f32_32x32x16_bf16 v[100:115], v[44:47], v[28:31], v[132:147]
    ds_read2st64_b64 v[48:51], v6 offset0:5 offset1:6
    ds_read_b64 v[54:55], v7 offset:4864
    v_exp_f32 v84, v84
    v_exp_f32 v85, v85
    v_exp_f32 v86, v86
    v_exp_f32 v87, v87
    v_mfma_f32_32x32x16_bf16 v[164:179], v[68:71], v[76:79], v[164:179]
    s_mov_b64 exec, s[22:23]
    ds_read_b128 v[64:67], v17 offset:3200
    ds_read_b128 v[60:63], v17 offset:3840
    s_mov_b64 exec, -1
    v_exp_f32 v88, v88
    v_exp_f32 v89, v89
    v_exp_f32 v90, v90
    v_exp_f32 v91, v91
    v_cvt_pk_bf16_f32 v72, v84, v85
    v_cvt_pk_bf16_f32 v73, v86, v87
    v_cvt_pk_bf16_f32 v74, v88, v89
    v_cvt_pk_bf16_f32 v75, v90, v91
    v_mfma_f32_32x32x8_bf16 v[100:115], v[52:53], v[34:35], v[100:115]
    v_exp_f32 v92, v92
    v_exp_f32 v93, v93
    v_exp_f32 v94, v94
    v_exp_f32 v95, v95
    v_mfma_f32_32x32x16_bf16 v[148:163], v[56:59], v[72:75], v[148:163]
    v_exp_f32 v96, v96
    v_exp_f32 v97, v97
    v_exp_f32 v98, v98
    v_exp_f32 v99, v99
    v_cvt_pk_bf16_f32 v76, v92, v93
    v_cvt_pk_bf16_f32 v77, v94, v95
    v_cvt_pk_bf16_f32 v78, v96, v97
    v_cvt_pk_bf16_f32 v79, v98, v99
    s_waitcnt lgkmcnt(0)
    v_mfma_f32_32x32x16_bf16 v[84:99], v[48:51], v[24:27], v[116:131]
    v_exp_f32 v100, v100
    v_exp_f32 v101, v101
    v_exp_f32 v102, v102
    v_exp_f32 v103, v103
    v_mfma_f32_32x32x16_bf16 v[148:163], v[64:67], v[76:79], v[148:163]
    s_add_u32 m0, s46, s29
    s_add_u32 s19, m0, s28
    buffer_load_dwordx4 v2, s[8:11], s19 offen lds
    v_exp_f32 v104, v104
    v_exp_f32 v105, v105
    v_exp_f32 v106, v106
    v_exp_f32 v107, v107
    v_cvt_pk_bf16_f32 v72, v100, v101
    v_cvt_pk_bf16_f32 v73, v102, v103
    v_cvt_pk_bf16_f32 v74, v104, v105
    v_cvt_pk_bf16_f32 v75, v106, v107
    v_mfma_f32_32x32x8_bf16 v[84:99], v[54:55], v[32:33], v[84:99]
    v_exp_f32 v108, v108
    v_exp_f32 v109, v109
    v_exp_f32 v110, v110
    v_exp_f32 v111, v111
    v_mfma_f32_32x32x16_bf16 v[164:179], v[56:59], v[72:75], v[164:179]
    v_exp_f32 v112, v112
    v_exp_f32 v113, v113
    v_exp_f32 v114, v114
    v_exp_f32 v115, v115
    v_cvt_pk_bf16_f32 v76, v108, v109
    v_cvt_pk_bf16_f32 v77, v110, v111
    v_cvt_pk_bf16_f32 v78, v112, v113
    v_cvt_pk_bf16_f32 v79, v114, v115
    v_mfma_f32_32x32x16_bf16 v[100:115], v[48:51], v[28:31], v[132:147]
    ds_read2st64_b64 v[44:47], v5 offset0:10 offset1:11
    ds_read_b64 v[52:53], v7 offset:6144
    v_exp_f32 v84, v84
    v_exp_f32 v85, v85
    v_exp_f32 v86, v86
    v_exp_f32 v87, v87
    v_mfma_f32_32x32x16_bf16 v[164:179], v[64:67], v[76:79], v[164:179]
    s_mov_b64 exec, s[22:23]
    ds_read_b128 v[68:71], v17 offset:4480
    ds_read_b128 v[56:59], v17 offset:5120
    s_mov_b64 exec, -1
    v_exp_f32 v88, v88
    v_exp_f32 v89, v89
    v_exp_f32 v90, v90
    v_exp_f32 v91, v91
    v_cvt_pk_bf16_f32 v72, v84, v85
    v_cvt_pk_bf16_f32 v73, v86, v87
    v_cvt_pk_bf16_f32 v74, v88, v89
    v_cvt_pk_bf16_f32 v75, v90, v91
    v_mfma_f32_32x32x8_bf16 v[100:115], v[54:55], v[34:35], v[100:115]
    v_exp_f32 v92, v92
    v_exp_f32 v93, v93
    v_exp_f32 v94, v94
    v_exp_f32 v95, v95
    v_mfma_f32_32x32x16_bf16 v[148:163], v[60:63], v[72:75], v[148:163]
    v_exp_f32 v96, v96
    v_exp_f32 v97, v97
    v_exp_f32 v98, v98
    v_exp_f32 v99, v99
    v_cvt_pk_bf16_f32 v76, v92, v93
    v_cvt_pk_bf16_f32 v77, v94, v95
    v_cvt_pk_bf16_f32 v78, v96, v97
    v_cvt_pk_bf16_f32 v79, v98, v99
    s_waitcnt lgkmcnt(0)
    v_mfma_f32_32x32x16_bf16 v[84:99], v[44:47], v[24:27], v[116:131]
    v_exp_f32 v100, v100
    v_exp_f32 v101, v101
    v_exp_f32 v102, v102
    v_exp_f32 v103, v103
    v_mfma_f32_32x32x16_bf16 v[148:163], v[68:71], v[76:79], v[148:163]
    s_add_u32 m0, s47, s29
    s_add_u32 s19, m0, s28
    buffer_load_dwordx4 v2, s[8:11], s19 offen lds
    v_exp_f32 v104, v104
    v_exp_f32 v105, v105
    v_exp_f32 v106, v106
    v_exp_f32 v107, v107
    v_cvt_pk_bf16_f32 v72, v100, v101
    v_cvt_pk_bf16_f32 v73, v102, v103
    v_cvt_pk_bf16_f32 v74, v104, v105
    v_cvt_pk_bf16_f32 v75, v106, v107
    v_mfma_f32_32x32x8_bf16 v[84:99], v[52:53], v[32:33], v[84:99]
    v_exp_f32 v108, v108
    v_exp_f32 v109, v109
    v_exp_f32 v110, v110
    v_exp_f32 v111, v111
    v_mfma_f32_32x32x16_bf16 v[164:179], v[60:63], v[72:75], v[164:179]
    v_exp_f32 v112, v112
    v_exp_f32 v113, v113
    v_exp_f32 v114, v114
    v_exp_f32 v115, v115
    v_cvt_pk_bf16_f32 v76, v108, v109
    v_cvt_pk_bf16_f32 v77, v110, v111
    v_cvt_pk_bf16_f32 v78, v112, v113
    v_cvt_pk_bf16_f32 v79, v114, v115
    v_mfma_f32_32x32x16_bf16 v[100:115], v[44:47], v[28:31], v[132:147]
    ds_read2st64_b64 v[48:51], v6 offset0:10 offset1:11
    ds_read_b64 v[54:55], v7 offset:7424
    v_exp_f32 v84, v84
    v_exp_f32 v85, v85
    v_exp_f32 v86, v86
    v_exp_f32 v87, v87
    v_mfma_f32_32x32x16_bf16 v[164:179], v[68:71], v[76:79], v[164:179]
    s_mov_b64 exec, s[22:23]
    ds_read_b128 v[64:67], v17 offset:5760
    ds_read_b128 v[60:63], v17 offset:6400
    s_mov_b64 exec, -1
    v_exp_f32 v88, v88
    v_exp_f32 v89, v89
    v_exp_f32 v90, v90
    v_exp_f32 v91, v91
    v_cvt_pk_bf16_f32 v72, v84, v85
    v_cvt_pk_bf16_f32 v73, v86, v87
    v_cvt_pk_bf16_f32 v74, v88, v89
    v_cvt_pk_bf16_f32 v75, v90, v91
    v_mfma_f32_32x32x8_bf16 v[100:115], v[52:53], v[34:35], v[100:115]
    v_exp_f32 v92, v92
    v_exp_f32 v93, v93
    v_exp_f32 v94, v94
    v_exp_f32 v95, v95
    v_mfma_f32_32x32x16_bf16 v[148:163], v[56:59], v[72:75], v[148:163]
    v_exp_f32 v96, v96
    v_exp_f32 v97, v97
    v_exp_f32 v98, v98
    v_exp_f32 v99, v99
    v_cvt_pk_bf16_f32 v76, v92, v93
    v_cvt_pk_bf16_f32 v77, v94, v95
    v_cvt_pk_bf16_f32 v78, v96, v97
    v_cvt_pk_bf16_f32 v79, v98, v99
    s_waitcnt lgkmcnt(0)
    v_mfma_f32_32x32x16_bf16 v[84:99], v[48:51], v[24:27], v[116:131]
    v_exp_f32 v100, v100
    v_exp_f32 v101, v101
    v_exp_f32 v102, v102
    v_exp_f32 v103, v103
    v_mfma_f32_32x32x16_bf16 v[148:163], v[64:67], v[76:79], v[148:163]
    s_add_u32 m0, s48, s29
    s_add_u32 s19, m0, s28
    buffer_load_dwordx4 v2, s[8:11], s19 offen lds
    s_add_u32 s29, s29, 20480
    v_exp_f32 v104, v104
    v_exp_f32 v105, v105
    v_exp_f32 v106, v106
    v_exp_f32 v107, v107
    v_cvt_pk_bf16_f32 v72, v100, v101
    v_cvt_pk_bf16_f32 v73, v102, v103
    v_cvt_pk_bf16_f32 v74, v104, v105
    v_cvt_pk_bf16_f32 v75, v106, v107
    v_mfma_f32_32x32x8_bf16 v[84:99], v[54:55], v[32:33], v[84:99]
    v_exp_f32 v108, v108
    v_exp_f32 v109, v109
    v_exp_f32 v110, v110
    v_exp_f32 v111, v111
    v_mfma_f32_32x32x16_bf16 v[164:179], v[56:59], v[72:75], v[164:179]
    v_exp_f32 v112, v112
    v_exp_f32 v113, v113
    v_exp_f32 v114, v114
    v_exp_f32 v115, v115
    v_cvt_pk_bf16_f32 v76, v108, v109
    v_cvt_pk_bf16_f32 v77, v110, v111
    v_cvt_pk_bf16_f32 v78, v112, v113
    v_cvt_pk_bf16_f32 v79, v114, v115
    v_mfma_f32_32x32x16_bf16 v[100:115], v[48:51], v[28:31], v[132:147]
    ds_read2st64_b64 v[44:47], v5 offset0:15 offset1:16
    ds_read_b64 v[52:53], v7 offset:8704
    v_exp_f32 v84, v84
    v_exp_f32 v85, v85
    v_exp_f32 v86, v86
    v_exp_f32 v87, v87
    v_mfma_f32_32x32x16_bf16 v[164:179], v[64:67], v[76:79], v[164:179]
    s_mov_b64 exec, s[22:23]
    ds_read_b128 v[68:71], v17 offset:7040
    ds_read_b128 v[56:59], v17 offset:7680
    s_mov_b64 exec, -1
    v_exp_f32 v88, v88
    v_exp_f32 v89, v89
    v_exp_f32 v90, v90
    v_exp_f32 v91, v91
    v_cvt_pk_bf16_f32 v72, v84, v85
    v_cvt_pk_bf16_f32 v73, v86, v87
    v_cvt_pk_bf16_f32 v74, v88, v89
    v_cvt_pk_bf16_f32 v75, v90, v91
    v_mfma_f32_32x32x8_bf16 v[100:115], v[54:55], v[34:35], v[100:115]
    v_exp_f32 v92, v92
    v_exp_f32 v93, v93
    v_exp_f32 v94, v94
    v_exp_f32 v95, v95
    v_mfma_f32_32x32x16_bf16 v[148:163], v[60:63], v[72:75], v[148:163]
    v_exp_f32 v96, v96
    v_exp_f32 v97, v97
    v_exp_f32 v98, v98
    v_exp_f32 v99, v99
    v_cvt_pk_bf16_f32 v76, v92, v93
    v_cvt_pk_bf16_f32 v77, v94, v95
    v_cvt_pk_bf16_f32 v78, v96, v97
    v_cvt_pk_bf16_f32 v79, v98, v99
    s_waitcnt lgkmcnt(0)
    v_mfma_f32_32x32x16_bf16 v[84:99], v[44:47], v[24:27], v[116:131]
    v_exp_f32 v100, v100
    v_exp_f32 v101, v101
    v_exp_f32 v102, v102
    v_exp_f32 v103, v103
    v_mfma_f32_32x32x16_bf16 v[148:163], v[68:71], v[76:79], v[148:163]
    v_exp_f32 v104, v104
    v_exp_f32 v105, v105
    v_exp_f32 v106, v106
    v_exp_f32 v107, v107
    v_cvt_pk_bf16_f32 v72, v100, v101
    v_cvt_pk_bf16_f32 v73, v102, v103
    v_cvt_pk_bf16_f32 v74, v104, v105
    v_cvt_pk_bf16_f32 v75, v106, v107
    v_mfma_f32_32x32x8_bf16 v[84:99], v[52:53], v[32:33], v[84:99]
    v_exp_f32 v108, v108
    v_exp_f32 v109, v109
    v_exp_f32 v110, v110
    v_exp_f32 v111, v111
    v_mfma_f32_32x32x16_bf16 v[164:179], v[60:63], v[72:75], v[164:179]
    v_exp_f32 v112, v112
    v_exp_f32 v113, v113
    v_exp_f32 v114, v114
    v_exp_f32 v115, v115
    v_cvt_pk_bf16_f32 v76, v108, v109
    v_cvt_pk_bf16_f32 v77, v110, v111
    v_cvt_pk_bf16_f32 v78, v112, v113
    v_cvt_pk_bf16_f32 v79, v114, v115
    s_setprio 0
    v_mfma_f32_32x32x16_bf16 v[100:115], v[44:47], v[28:31], v[132:147]
    ds_read2st64_b64 v[48:51], v6 offset0:15 offset1:16
    ds_read_b64 v[54:55], v7 offset:9984
    v_exp_f32 v84, v84
    v_exp_f32 v85, v85
    v_exp_f32 v86, v86
    v_exp_f32 v87, v87
    v_mfma_f32_32x32x16_bf16 v[164:179], v[68:71], v[76:79], v[164:179]
    s_mov_b64 exec, s[22:23]
    ds_read_b128 v[64:67], v17 offset:8320
    ds_read_b128 v[60:63], v17 offset:8960
    s_mov_b64 exec, -1
    v_exp_f32 v88, v88
    v_exp_f32 v89, v89
    v_exp_f32 v90, v90
    v_exp_f32 v91, v91
    v_cvt_pk_bf16_f32 v72, v84, v85
    v_cvt_pk_bf16_f32 v73, v86, v87
    v_cvt_pk_bf16_f32 v74, v88, v89
    v_cvt_pk_bf16_f32 v75, v90, v91
    v_mfma_f32_32x32x8_bf16 v[100:115], v[52:53], v[34:35], v[100:115]
    v_exp_f32 v92, v92
    v_exp_f32 v93, v93
    v_exp_f32 v94, v94
    v_exp_f32 v95, v95
    v_mfma_f32_32x32x16_bf16 v[148:163], v[56:59], v[72:75], v[148:163]
    v_exp_f32 v96, v96
    v_exp_f32 v97, v97
    v_exp_f32 v98, v98
    v_exp_f32 v99, v99
    v_cvt_pk_bf16_f32 v76, v92, v93
    v_cvt_pk_bf16_f32 v77, v94, v95
    v_cvt_pk_bf16_f32 v78, v96, v97
    v_cvt_pk_bf16_f32 v79, v98, v99
    s_waitcnt lgkmcnt(0)
    v_mfma_f32_32x32x16_bf16 v[84:99], v[48:51], v[24:27], v[116:131]
    v_exp_f32 v100, v100
    v_exp_f32 v101, v101
    v_exp_f32 v102, v102
    v_exp_f32 v103, v103
    v_mfma_f32_32x32x16_bf16 v[148:163], v[64:67], v[76:79], v[148:163]
    v_exp_f32 v104, v104
    v_exp_f32 v105, v105
    v_exp_f32 v106, v106
    v_exp_f32 v107, v107
    v_cvt_pk_bf16_f32 v72, v100, v101
    v_cvt_pk_bf16_f32 v73, v102, v103
    v_cvt_pk_bf16_f32 v74, v104, v105
    v_cvt_pk_bf16_f32 v75, v106, v107
    v_mfma_f32_32x32x8_bf16 v[84:99], v[54:55], v[32:33], v[84:99]
    v_exp_f32 v108, v108
    v_exp_f32 v109, v109
    v_exp_f32 v110, v110
    v_exp_f32 v111, v111
    v_mfma_f32_32x32x16_bf16 v[164:179], v[56:59], v[72:75], v[164:179]
    v_exp_f32 v112, v112
    v_exp_f32 v113, v113
    v_exp_f32 v114, v114
    v_exp_f32 v115, v115
    v_cvt_pk_bf16_f32 v76, v108, v109
    v_cvt_pk_bf16_f32 v77, v110, v111
    v_cvt_pk_bf16_f32 v78, v112, v113
    v_cvt_pk_bf16_f32 v79, v114, v115
    s_waitcnt vmcnt(0)
    s_barrier
    s_setprio 2
    v_mfma_f32_32x32x16_bf16 v[100:115], v[48:51], v[28:31], v[132:147]
    ds_read2st64_b64 v[44:47], v5 offset0:40 offset1:41
    ds_read_b64 v[52:53], v7 offset:21504
    v_exp_f32 v84, v84
    v_exp_f32 v85, v85
    v_exp_f32 v86, v86
    v_exp_f32 v87, v87
    v_mfma_f32_32x32x16_bf16 v[164:179], v[64:67], v[76:79], v[164:179]
    s_mov_b64 exec, s[22:23]
    ds_read_b128 v[68:71], v17 offset:9600
    ds_read_b128 v[56:59], v17 offset:20480
    s_mov_b64 exec, -1
    v_exp_f32 v88, v88
    v_exp_f32 v89, v89
    v_exp_f32 v90, v90
    v_exp_f32 v91, v91
    v_cvt_pk_bf16_f32 v72, v84, v85
    v_cvt_pk_bf16_f32 v73, v86, v87
    v_cvt_pk_bf16_f32 v74, v88, v89
    v_cvt_pk_bf16_f32 v75, v90, v91
    v_mfma_f32_32x32x8_bf16 v[100:115], v[54:55], v[34:35], v[100:115]
    v_exp_f32 v92, v92
    v_exp_f32 v93, v93
    v_exp_f32 v94, v94
    v_exp_f32 v95, v95
    v_mfma_f32_32x32x16_bf16 v[148:163], v[60:63], v[72:75], v[148:163]
    v_exp_f32 v96, v96
    v_exp_f32 v97, v97
    v_exp_f32 v98, v98
    v_exp_f32 v99, v99
    v_cvt_pk_bf16_f32 v76, v92, v93
    v_cvt_pk_bf16_f32 v77, v94, v95
    v_cvt_pk_bf16_f32 v78, v96, v97
    v_cvt_pk_bf16_f32 v79, v98, v99
    s_waitcnt lgkmcnt(0)
    v_mfma_f32_32x32x16_bf16 v[84:99], v[44:47], v[24:27], v[116:131]
    v_exp_f32 v100, v100
    v_exp_f32 v101, v101
    v_exp_f32 v102, v102
    v_exp_f32 v103, v103
    v_mfma_f32_32x32x16_bf16 v[148:163], v[68:71], v[76:79], v[148:163]
    v_exp_f32 v104, v104
    v_exp_f32 v105, v105
    v_exp_f32 v106, v106
    v_exp_f32 v107, v107
    v_cvt_pk_bf16_f32 v72, v100, v101
    v_cvt_pk_bf16_f32 v73, v102, v103
    v_cvt_pk_bf16_f32 v74, v104, v105
    v_cvt_pk_bf16_f32 v75, v106, v107
    v_mfma_f32_32x32x8_bf16 v[84:99], v[52:53], v[32:33], v[84:99]
    v_exp_f32 v108, v108
    v_exp_f32 v109, v109
    v_exp_f32 v110, v110
    v_exp_f32 v111, v111
    v_mfma_f32_32x32x16_bf16 v[164:179], v[60:63], v[72:75], v[164:179]
    v_exp_f32 v112, v112
    v_exp_f32 v113, v113
    v_exp_f32 v114, v114
    v_exp_f32 v115, v115
    v_cvt_pk_bf16_f32 v76, v108, v109
    v_cvt_pk_bf16_f32 v77, v110, v111
    v_cvt_pk_bf16_f32 v78, v112, v113
    v_cvt_pk_bf16_f32 v79, v114, v115
    v_add_u32 v5, 20480, v5
    v_add_u32 v6, 20480, v6
    v_add_u32 v7, 20480, v7
    v_add_u32 v17, 20480, v17
    v_mfma_f32_32x32x16_bf16 v[100:115], v[44:47], v[28:31], v[132:147]
    ds_read2st64_b64 v[48:51], v6 offset0:0 offset1:1
    ds_read_b64 v[54:55], v7 offset:2304
    v_exp_f32 v84, v84
    v_exp_f32 v85, v85
    v_exp_f32 v86, v86
    v_exp_f32 v87, v87
    v_mfma_f32_32x32x16_bf16 v[164:179], v[68:71], v[76:79], v[164:179]
    s_mov_b64 exec, s[22:23]
    ds_read_b128 v[64:67], v17 offset:640
    ds_read_b128 v[60:63], v17 offset:1280
    s_mov_b64 exec, -1
    v_exp_f32 v88, v88
    v_exp_f32 v89, v89
    v_exp_f32 v90, v90
    v_exp_f32 v91, v91
    v_cvt_pk_bf16_f32 v72, v84, v85
    v_cvt_pk_bf16_f32 v73, v86, v87
    v_cvt_pk_bf16_f32 v74, v88, v89
    v_cvt_pk_bf16_f32 v75, v90, v91
    v_mfma_f32_32x32x8_bf16 v[100:115], v[52:53], v[34:35], v[100:115]
    v_exp_f32 v92, v92
    v_exp_f32 v93, v93
    v_exp_f32 v94, v94
    v_exp_f32 v95, v95
    v_mfma_f32_32x32x16_bf16 v[148:163], v[56:59], v[72:75], v[148:163]
    v_exp_f32 v96, v96
    v_exp_f32 v97, v97
    v_exp_f32 v98, v98
    v_exp_f32 v99, v99
    v_cvt_pk_bf16_f32 v76, v92, v93
    v_cvt_pk_bf16_f32 v77, v94, v95
    v_cvt_pk_bf16_f32 v78, v96, v97
    v_cvt_pk_bf16_f32 v79, v98, v99
    s_waitcnt lgkmcnt(0)
    v_mfma_f32_32x32x16_bf16 v[84:99], v[48:51], v[24:27], v[116:131]
    v_exp_f32 v100, v100
    v_exp_f32 v101, v101
    v_exp_f32 v102, v102
    v_exp_f32 v103, v103
    v_mfma_f32_32x32x16_bf16 v[148:163], v[64:67], v[76:79], v[148:163]
    s_add_u32 m0, s44, s29
    s_add_u32 s19, m0, s28
    buffer_load_dwordx4 v2, s[8:11], s19 offen lds
    v_exp_f32 v104, v104
    v_exp_f32 v105, v105
    v_exp_f32 v106, v106
    v_exp_f32 v107, v107
    v_cvt_pk_bf16_f32 v72, v100, v101
    v_cvt_pk_bf16_f32 v73, v102, v103
    v_cvt_pk_bf16_f32 v74, v104, v105
    v_cvt_pk_bf16_f32 v75, v106, v107
    v_mfma_f32_32x32x8_bf16 v[84:99], v[54:55], v[32:33], v[84:99]
    v_exp_f32 v108, v108
    v_exp_f32 v109, v109
    v_exp_f32 v110, v110
    v_exp_f32 v111, v111
    v_mfma_f32_32x32x16_bf16 v[164:179], v[56:59], v[72:75], v[164:179]
    v_exp_f32 v112, v112
    v_exp_f32 v113, v113
    v_exp_f32 v114, v114
    v_exp_f32 v115, v115
    v_cvt_pk_bf16_f32 v76, v108, v109
    v_cvt_pk_bf16_f32 v77, v110, v111
    v_cvt_pk_bf16_f32 v78, v112, v113
    v_cvt_pk_bf16_f32 v79, v114, v115
    v_mfma_f32_32x32x16_bf16 v[100:115], v[48:51], v[28:31], v[132:147]
    ds_read2st64_b64 v[44:47], v5 offset0:5 offset1:6
    ds_read_b64 v[52:53], v7 offset:3584
    v_exp_f32 v84, v84
    v_exp_f32 v85, v85
    v_exp_f32 v86, v86
    v_exp_f32 v87, v87
    v_mfma_f32_32x32x16_bf16 v[164:179], v[64:67], v[76:79], v[164:179]
    s_mov_b64 exec, s[22:23]
    ds_read_b128 v[68:71], v17 offset:1920
    ds_read_b128 v[56:59], v17 offset:2560
    s_mov_b64 exec, -1
    v_exp_f32 v88, v88
    v_exp_f32 v89, v89
    v_exp_f32 v90, v90
    v_exp_f32 v91, v91
    v_cvt_pk_bf16_f32 v72, v84, v85
    v_cvt_pk_bf16_f32 v73, v86, v87
    v_cvt_pk_bf16_f32 v74, v88, v89
    v_cvt_pk_bf16_f32 v75, v90, v91
    v_mfma_f32_32x32x8_bf16 v[100:115], v[54:55], v[34:35], v[100:115]
    v_exp_f32 v92, v92
    v_exp_f32 v93, v93
    v_exp_f32 v94, v94
    v_exp_f32 v95, v95
    v_mfma_f32_32x32x16_bf16 v[148:163], v[60:63], v[72:75], v[148:163]
    v_exp_f32 v96, v96
    v_exp_f32 v97, v97
    v_exp_f32 v98, v98
    v_exp_f32 v99, v99
    v_cvt_pk_bf16_f32 v76, v92, v93
    v_cvt_pk_bf16_f32 v77, v94, v95
    v_cvt_pk_bf16_f32 v78, v96, v97
    v_cvt_pk_bf16_f32 v79, v98, v99
    s_waitcnt lgkmcnt(0)
    v_mfma_f32_32x32x16_bf16 v[84:99], v[44:47], v[24:27], v[116:131]
    v_exp_f32 v100, v100
    v_exp_f32 v101, v101
    v_exp_f32 v102, v102
    v_exp_f32 v103, v103
    v_mfma_f32_32x32x16_bf16 v[148:163], v[68:71], v[76:79], v[148:163]
    s_add_u32 m0, s45, s29
    s_add_u32 s19, m0, s28
    buffer_load_dwordx4 v2, s[8:11], s19 offen lds
    v_exp_f32 v104, v104
    v_exp_f32 v105, v105
    v_exp_f32 v106, v106
    v_exp_f32 v107, v107
    v_cvt_pk_bf16_f32 v72, v100, v101
    v_cvt_pk_bf16_f32 v73, v102, v103
    v_cvt_pk_bf16_f32 v74, v104, v105
    v_cvt_pk_bf16_f32 v75, v106, v107
    v_mfma_f32_32x32x8_bf16 v[84:99], v[52:53], v[32:33], v[84:99]
    v_exp_f32 v108, v108
    v_exp_f32 v109, v109
    v_exp_f32 v110, v110
    v_exp_f32 v111, v111
    v_mfma_f32_32x32x16_bf16 v[164:179], v[60:63], v[72:75], v[164:179]
    v_exp_f32 v112, v112
    v_exp_f32 v113, v113
    v_exp_f32 v114, v114
    v_exp_f32 v115, v115
    v_cvt_pk_bf16_f32 v76, v108, v109
    v_cvt_pk_bf16_f32 v77, v110, v111
    v_cvt_pk_bf16_f32 v78, v112, v113
    v_cvt_pk_bf16_f32 v79, v114, v115
    v_mfma_f32_32x32x16_bf16 v[100:115], v[44:47], v[28:31], v[132:147]
    ds_read2st64_b64 v[48:51], v6 offset0:5 offset1:6
    ds_read_b64 v[54:55], v7 offset:4864
    v_exp_f32 v84, v84
    v_exp_f32 v85, v85
    v_exp_f32 v86, v86
    v_exp_f32 v87, v87
    v_mfma_f32_32x32x16_bf16 v[164:179], v[68:71], v[76:79], v[164:179]
    s_mov_b64 exec, s[22:23]
    ds_read_b128 v[64:67], v17 offset:3200
    ds_read_b128 v[60:63], v17 offset:3840
    s_mov_b64 exec, -1
    v_exp_f32 v88, v88
    v_exp_f32 v89, v89
    v_exp_f32 v90, v90
    v_exp_f32 v91, v91
    v_cvt_pk_bf16_f32 v72, v84, v85
    v_cvt_pk_bf16_f32 v73, v86, v87
    v_cvt_pk_bf16_f32 v74, v88, v89
    v_cvt_pk_bf16_f32 v75, v90, v91
    v_mfma_f32_32x32x8_bf16 v[100:115], v[52:53], v[34:35], v[100:115]
    v_exp_f32 v92, v92
    v_exp_f32 v93, v93
    v_exp_f32 v94, v94
    v_exp_f32 v95, v95
    v_mfma_f32_32x32x16_bf16 v[148:163], v[56:59], v[72:75], v[148:163]
    v_exp_f32 v96, v96
    v_exp_f32 v97, v97
    v_exp_f32 v98, v98
    v_exp_f32 v99, v99
    v_cvt_pk_bf16_f32 v76, v92, v93
    v_cvt_pk_bf16_f32 v77, v94, v95
    v_cvt_pk_bf16_f32 v78, v96, v97
    v_cvt_pk_bf16_f32 v79, v98, v99
    s_waitcnt lgkmcnt(0)
    v_mfma_f32_32x32x16_bf16 v[84:99], v[48:51], v[24:27], v[116:131]
    v_exp_f32 v100, v100
    v_exp_f32 v101, v101
    v_exp_f32 v102, v102
    v_exp_f32 v103, v103
    v_mfma_f32_32x32x16_bf16 v[148:163], v[64:67], v[76:79], v[148:163]
    s_add_u32 m0, s46, s29
    s_add_u32 s19, m0, s28
    buffer_load_dwordx4 v2, s[8:11], s19 offen lds
    v_exp_f32 v104, v104
    v_exp_f32 v105, v105
    v_exp_f32 v106, v106
    v_exp_f32 v107, v107
    v_cvt_pk_bf16_f32 v72, v100, v101
    v_cvt_pk_bf16_f32 v73, v102, v103
    v_cvt_pk_bf16_f32 v74, v104, v105
    v_cvt_pk_bf16_f32 v75, v106, v107
    v_mfma_f32_32x32x8_bf16 v[84:99], v[54:55], v[32:33], v[84:99]
    v_exp_f32 v108, v108
    v_exp_f32 v109, v109
    v_exp_f32 v110, v110
    v_exp_f32 v111, v111
    v_mfma_f32_32x32x16_bf16 v[164:179], v[56:59], v[72:75], v[164:179]
    v_exp_f32 v112, v112
    v_exp_f32 v113, v113
    v_exp_f32 v114, v114
    v_exp_f32 v115, v115
    v_cvt_pk_bf16_f32 v76, v108, v109
    v_cvt_pk_bf16_f32 v77, v110, v111
    v_cvt_pk_bf16_f32 v78, v112, v113
    v_cvt_pk_bf16_f32 v79, v114, v115
    v_mfma_f32_32x32x16_bf16 v[100:115], v[48:51], v[28:31], v[132:147]
    ds_read2st64_b64 v[44:47], v5 offset0:10 offset1:11
    ds_read_b64 v[52:53], v7 offset:6144
    v_exp_f32 v84, v84
    v_exp_f32 v85, v85
    v_exp_f32 v86, v86
    v_exp_f32 v87, v87
    v_mfma_f32_32x32x16_bf16 v[164:179], v[64:67], v[76:79], v[164:179]
    s_mov_b64 exec, s[22:23]
    ds_read_b128 v[68:71], v17 offset:4480
    ds_read_b128 v[56:59], v17 offset:5120
    s_mov_b64 exec, -1
    v_exp_f32 v88, v88
    v_exp_f32 v89, v89
    v_exp_f32 v90, v90
    v_exp_f32 v91, v91
    v_cvt_pk_bf16_f32 v72, v84, v85
    v_cvt_pk_bf16_f32 v73, v86, v87
    v_cvt_pk_bf16_f32 v74, v88, v89
    v_cvt_pk_bf16_f32 v75, v90, v91
    v_mfma_f32_32x32x8_bf16 v[100:115], v[54:55], v[34:35], v[100:115]
    v_exp_f32 v92, v92
    v_exp_f32 v93, v93
    v_exp_f32 v94, v94
    v_exp_f32 v95, v95
    v_mfma_f32_32x32x16_bf16 v[148:163], v[60:63], v[72:75], v[148:163]
    v_exp_f32 v96, v96
    v_exp_f32 v97, v97
    v_exp_f32 v98, v98
    v_exp_f32 v99, v99
    v_cvt_pk_bf16_f32 v76, v92, v93
    v_cvt_pk_bf16_f32 v77, v94, v95
    v_cvt_pk_bf16_f32 v78, v96, v97
    v_cvt_pk_bf16_f32 v79, v98, v99
    s_waitcnt lgkmcnt(0)
    v_mfma_f32_32x32x16_bf16 v[84:99], v[44:47], v[24:27], v[116:131]
    v_exp_f32 v100, v100
    v_exp_f32 v101, v101
    v_exp_f32 v102, v102
    v_exp_f32 v103, v103
    v_mfma_f32_32x32x16_bf16 v[148:163], v[68:71], v[76:79], v[148:163]
    s_add_u32 m0, s47, s29
    s_add_u32 s19, m0, s28
    buffer_load_dwordx4 v2, s[8:11], s19 offen lds
    v_exp_f32 v104, v104
    v_exp_f32 v105, v105
    v_exp_f32 v106, v106
    v_exp_f32 v107, v107
    v_cvt_pk_bf16_f32 v72, v100, v101
    v_cvt_pk_bf16_f32 v73, v102, v103
    v_cvt_pk_bf16_f32 v74, v104, v105
    v_cvt_pk_bf16_f32 v75, v106, v107
    v_mfma_f32_32x32x8_bf16 v[84:99], v[52:53], v[32:33], v[84:99]
    v_exp_f32 v108, v108
    v_exp_f32 v109, v109
    v_exp_f32 v110, v110
    v_exp_f32 v111, v111
    v_mfma_f32_32x32x16_bf16 v[164:179], v[60:63], v[72:75], v[164:179]
    v_exp_f32 v112, v112
    v_exp_f32 v113, v113
    v_exp_f32 v114, v114
    v_exp_f32 v115, v115
    v_cvt_pk_bf16_f32 v76, v108, v109
    v_cvt_pk_bf16_f32 v77, v110, v111
    v_cvt_pk_bf16_f32 v78, v112, v113
    v_cvt_pk_bf16_f32 v79, v114, v115
    v_mfma_f32_32x32x16_bf16 v[100:115], v[44:47], v[28:31], v[132:147]
    ds_read2st64_b64 v[48:51], v6 offset0:10 offset1:11
    ds_read_b64 v[54:55], v7 offset:7424
    v_exp_f32 v84, v84
    v_exp_f32 v85, v85
    v_exp_f32 v86, v86
    v_exp_f32 v87, v87
    v_mfma_f32_32x32x16_bf16 v[164:179], v[68:71], v[76:79], v[164:179]
    s_mov_b64 exec, s[22:23]
    ds_read_b128 v[64:67], v17 offset:5760
    ds_read_b128 v[60:63], v17 offset:6400
    s_mov_b64 exec, -1
    v_exp_f32 v88, v88
    v_exp_f32 v89, v89
    v_exp_f32 v90, v90
    v_exp_f32 v91, v91
    v_cvt_pk_bf16_f32 v72, v84, v85
    v_cvt_pk_bf16_f32 v73, v86, v87
    v_cvt_pk_bf16_f32 v74, v88, v89
    v_cvt_pk_bf16_f32 v75, v90, v91
    v_mfma_f32_32x32x8_bf16 v[100:115], v[52:53], v[34:35], v[100:115]
    v_exp_f32 v92, v92
    v_exp_f32 v93, v93
    v_exp_f32 v94, v94
    v_exp_f32 v95, v95
    v_mfma_f32_32x32x16_bf16 v[148:163], v[56:59], v[72:75], v[148:163]
    v_exp_f32 v96, v96
    v_exp_f32 v97, v97
    v_exp_f32 v98, v98
    v_exp_f32 v99, v99
    v_cvt_pk_bf16_f32 v76, v92, v93
    v_cvt_pk_bf16_f32 v77, v94, v95
    v_cvt_pk_bf16_f32 v78, v96, v97
    v_cvt_pk_bf16_f32 v79, v98, v99
    s_waitcnt lgkmcnt(0)
    v_mfma_f32_32x32x16_bf16 v[84:99], v[48:51], v[24:27], v[116:131]
    v_exp_f32 v100, v100
    v_exp_f32 v101, v101
    v_exp_f32 v102, v102
    v_exp_f32 v103, v103
    v_mfma_f32_32x32x16_bf16 v[148:163], v[64:67], v[76:79], v[148:163]
    s_add_u32 m0, s48, s29
    s_add_u32 s19, m0, s28
    buffer_load_dwordx4 v2, s[8:11], s19 offen lds
    s_add_u32 s29, s29, 20480
    v_exp_f32 v104, v104
    v_exp_f32 v105, v105
    v_exp_f32 v106, v106
    v_exp_f32 v107, v107
    v_cvt_pk_bf16_f32 v72, v100, v101
    v_cvt_pk_bf16_f32 v73, v102, v103
    v_cvt_pk_bf16_f32 v74, v104, v105
    v_cvt_pk_bf16_f32 v75, v106, v107
    v_mfma_f32_32x32x8_bf16 v[84:99], v[54:55], v[32:33], v[84:99]
    v_exp_f32 v108, v108
    v_exp_f32 v109, v109
    v_exp_f32 v110, v110
    v_exp_f32 v111, v111
    v_mfma_f32_32x32x16_bf16 v[164:179], v[56:59], v[72:75], v[164:179]
    v_exp_f32 v112, v112
    v_exp_f32 v113, v113
    v_exp_f32 v114, v114
    v_exp_f32 v115, v115
    v_cvt_pk_bf16_f32 v76, v108, v109
    v_cvt_pk_bf16_f32 v77, v110, v111
    v_cvt_pk_bf16_f32 v78, v112, v113
    v_cvt_pk_bf16_f32 v79, v114, v115
    v_mfma_f32_32x32x16_bf16 v[100:115], v[48:51], v[28:31], v[132:147]
    ds_read2st64_b64 v[44:47], v5 offset0:15 offset1:16
    ds_read_b64 v[52:53], v7 offset:8704
    v_exp_f32 v84, v84
    v_exp_f32 v85, v85
    v_exp_f32 v86, v86
    v_exp_f32 v87, v87
    v_mfma_f32_32x32x16_bf16 v[164:179], v[64:67], v[76:79], v[164:179]
    s_mov_b64 exec, s[22:23]
    ds_read_b128 v[68:71], v17 offset:7040
    ds_read_b128 v[56:59], v17 offset:7680
    s_mov_b64 exec, -1
    v_exp_f32 v88, v88
    v_exp_f32 v89, v89
    v_exp_f32 v90, v90
    v_exp_f32 v91, v91
    v_cvt_pk_bf16_f32 v72, v84, v85
    v_cvt_pk_bf16_f32 v73, v86, v87
    v_cvt_pk_bf16_f32 v74, v88, v89
    v_cvt_pk_bf16_f32 v75, v90, v91
    v_mfma_f32_32x32x8_bf16 v[100:115], v[54:55], v[34:35], v[100:115]
    v_exp_f32 v92, v92
    v_exp_f32 v93, v93
    v_exp_f32 v94, v94
    v_exp_f32 v95, v95
    v_mfma_f32_32x32x16_bf16 v[148:163], v[60:63], v[72:75], v[148:163]
    v_exp_f32 v96, v96
    v_exp_f32 v97, v97
    v_exp_f32 v98, v98
    v_exp_f32 v99, v99
    v_cvt_pk_bf16_f32 v76, v92, v93
    v_cvt_pk_bf16_f32 v77, v94, v95
    v_cvt_pk_bf16_f32 v78, v96, v97
    v_cvt_pk_bf16_f32 v79, v98, v99
    s_waitcnt lgkmcnt(0)
    v_mfma_f32_32x32x16_bf16 v[84:99], v[44:47], v[24:27], v[116:131]
    v_exp_f32 v100, v100
    v_exp_f32 v101, v101
    v_exp_f32 v102, v102
    v_exp_f32 v103, v103
    v_mfma_f32_32x32x16_bf16 v[148:163], v[68:71], v[76:79], v[148:163]
    v_exp_f32 v104, v104
    v_exp_f32 v105, v105
    v_exp_f32 v106, v106
    v_exp_f32 v107, v107
    v_cvt_pk_bf16_f32 v72, v100, v101
    v_cvt_pk_bf16_f32 v73, v102, v103
    v_cvt_pk_bf16_f32 v74, v104, v105
    v_cvt_pk_bf16_f32 v75, v106, v107
    v_mfma_f32_32x32x8_bf16 v[84:99], v[52:53], v[32:33], v[84:99]
    v_exp_f32 v108, v108
    v_exp_f32 v109, v109
    v_exp_f32 v110, v110
    v_exp_f32 v111, v111
    v_mfma_f32_32x32x16_bf16 v[164:179], v[60:63], v[72:75], v[164:179]
    v_exp_f32 v112, v112
    v_exp_f32 v113, v113
    v_exp_f32 v114, v114
    v_exp_f32 v115, v115
    v_cvt_pk_bf16_f32 v76, v108, v109
    v_cvt_pk_bf16_f32 v77, v110, v111
    v_cvt_pk_bf16_f32 v78, v112, v113
    v_cvt_pk_bf16_f32 v79, v114, v115
    s_setprio 0
    v_mfma_f32_32x32x16_bf16 v[100:115], v[44:47], v[28:31], v[132:147]
    ds_read2st64_b64 v[48:51], v6 offset0:15 offset1:16
    ds_read_b64 v[54:55], v7 offset:9984
    v_exp_f32 v84, v84
    v_exp_f32 v85, v85
    v_exp_f32 v86, v86
    v_exp_f32 v87, v87
    v_mfma_f32_32x32x16_bf16 v[164:179], v[68:71], v[76:79], v[164:179]
    s_mov_b64 exec, s[22:23]
    ds_read_b128 v[64:67], v17 offset:8320
    ds_read_b128 v[60:63], v17 offset:8960
    s_mov_b64 exec, -1
    v_exp_f32 v88, v88
    v_exp_f32 v89, v89
    v_exp_f32 v90, v90
    v_exp_f32 v91, v91
    v_cvt_pk_bf16_f32 v72, v84, v85
    v_cvt_pk_bf16_f32 v73, v86, v87
    v_cvt_pk_bf16_f32 v74, v88, v89
    v_cvt_pk_bf16_f32 v75, v90, v91
    v_mfma_f32_32x32x8_bf16 v[100:115], v[52:53], v[34:35], v[100:115]
    v_exp_f32 v92, v92
    v_exp_f32 v93, v93
    v_exp_f32 v94, v94
    v_exp_f32 v95, v95
    v_mfma_f32_32x32x16_bf16 v[148:163], v[56:59], v[72:75], v[148:163]
    v_exp_f32 v96, v96
    v_exp_f32 v97, v97
    v_exp_f32 v98, v98
    v_exp_f32 v99, v99
    v_cvt_pk_bf16_f32 v76, v92, v93
    v_cvt_pk_bf16_f32 v77, v94, v95
    v_cvt_pk_bf16_f32 v78, v96, v97
    v_cvt_pk_bf16_f32 v79, v98, v99
    s_waitcnt lgkmcnt(0)
    v_mfma_f32_32x32x16_bf16 v[84:99], v[48:51], v[24:27], v[116:131]
    v_exp_f32 v100, v100
    v_exp_f32 v101, v101
    v_exp_f32 v102, v102
    v_exp_f32 v103, v103
    v_mfma_f32_32x32x16_bf16 v[148:163], v[64:67], v[76:79], v[148:163]
    v_exp_f32 v104, v104
    v_exp_f32 v105, v105
    v_exp_f32 v106, v106
    v_exp_f32 v107, v107
    v_cvt_pk_bf16_f32 v72, v100, v101
    v_cvt_pk_bf16_f32 v73, v102, v103
    v_cvt_pk_bf16_f32 v74, v104, v105
    v_cvt_pk_bf16_f32 v75, v106, v107
    v_mfma_f32_32x32x8_bf16 v[84:99], v[54:55], v[32:33], v[84:99]
    v_exp_f32 v108, v108
    v_exp_f32 v109, v109
    v_exp_f32 v110, v110
    v_exp_f32 v111, v111
    v_mfma_f32_32x32x16_bf16 v[164:179], v[56:59], v[72:75], v[164:179]
    v_exp_f32 v112, v112
    v_exp_f32 v113, v113
    v_exp_f32 v114, v114
    v_exp_f32 v115, v115
    v_cvt_pk_bf16_f32 v76, v108, v109
    v_cvt_pk_bf16_f32 v77, v110, v111
    v_cvt_pk_bf16_f32 v78, v112, v113
    v_cvt_pk_bf16_f32 v79, v114, v115
    s_waitcnt vmcnt(0)
    s_barrier
    s_setprio 2
    v_mfma_f32_32x32x16_bf16 v[100:115], v[48:51], v[28:31], v[132:147]
    ds_read2st64_b64 v[44:47], v5 offset0:40 offset1:41
    ds_read_b64 v[52:53], v7 offset:21504
    v_exp_f32 v84, v84
    v_exp_f32 v85, v85
    v_exp_f32 v86, v86
    v_exp_f32 v87, v87
    v_mfma_f32_32x32x16_bf16 v[164:179], v[64:67], v[76:79], v[164:179]
    s_mov_b64 exec, s[22:23]
    ds_read_b128 v[68:71], v17 offset:9600
    ds_read_b128 v[56:59], v17 offset:20480
    s_mov_b64 exec, -1
    v_exp_f32 v88, v88
    v_exp_f32 v89, v89
    v_exp_f32 v90, v90
    v_exp_f32 v91, v91
    v_cvt_pk_bf16_f32 v72, v84, v85
    v_cvt_pk_bf16_f32 v73, v86, v87
    v_cvt_pk_bf16_f32 v74, v88, v89
    v_cvt_pk_bf16_f32 v75, v90, v91
    v_mfma_f32_32x32x8_bf16 v[100:115], v[54:55], v[34:35], v[100:115]
    v_exp_f32 v92, v92
    v_exp_f32 v93, v93
    v_exp_f32 v94, v94
    v_exp_f32 v95, v95
    v_mfma_f32_32x32x16_bf16 v[148:163], v[60:63], v[72:75], v[148:163]
    v_exp_f32 v96, v96
    v_exp_f32 v97, v97
    v_exp_f32 v98, v98
    v_exp_f32 v99, v99
    v_cvt_pk_bf16_f32 v76, v92, v93
    v_cvt_pk_bf16_f32 v77, v94, v95
    v_cvt_pk_bf16_f32 v78, v96, v97
    v_cvt_pk_bf16_f32 v79, v98, v99
    s_waitcnt lgkmcnt(0)
    v_mfma_f32_32x32x16_bf16 v[84:99], v[44:47], v[24:27], v[116:131]
    v_exp_f32 v100, v100
    v_exp_f32 v101, v101
    v_exp_f32 v102, v102
    v_exp_f32 v103, v103
    v_mfma_f32_32x32x16_bf16 v[148:163], v[68:71], v[76:79], v[148:163]
    v_exp_f32 v104, v104
    v_exp_f32 v105, v105
    v_exp_f32 v106, v106
    v_exp_f32 v107, v107
    v_cvt_pk_bf16_f32 v72, v100, v101
    v_cvt_pk_bf16_f32 v73, v102, v103
    v_cvt_pk_bf16_f32 v74, v104, v105
    v_cvt_pk_bf16_f32 v75, v106, v107
    v_mfma_f32_32x32x8_bf16 v[84:99], v[52:53], v[32:33], v[84:99]
    v_exp_f32 v108, v108
    v_exp_f32 v109, v109
    v_exp_f32 v110, v110
    v_exp_f32 v111, v111
    v_mfma_f32_32x32x16_bf16 v[164:179], v[60:63], v[72:75], v[164:179]
    v_exp_f32 v112, v112
    v_exp_f32 v113, v113
    v_exp_f32 v114, v114
    v_exp_f32 v115, v115
    v_cvt_pk_bf16_f32 v76, v108, v109
    v_cvt_pk_bf16_f32 v77, v110, v111
    v_cvt_pk_bf16_f32 v78, v112, v113
    v_cvt_pk_bf16_f32 v79, v114, v115
    v_add_u32 v5, 20480, v5
    v_add_u32 v6, 20480, v6
    v_add_u32 v7, 20480, v7
    v_add_u32 v17, 20480, v17
    v_mfma_f32_32x32x16_bf16 v[100:115], v[44:47], v[28:31], v[132:147]
    ds_read2st64_b64 v[48:51], v6 offset0:0 offset1:1
    ds_read_b64 v[54:55], v7 offset:2304
    v_exp_f32 v84, v84
    v_exp_f32 v85, v85
    v_exp_f32 v86, v86
    v_exp_f32 v87, v87
    v_mfma_f32_32x32x16_bf16 v[164:179], v[68:71], v[76:79], v[164:179]
    s_mov_b64 exec, s[22:23]
    ds_read_b128 v[64:67], v17 offset:640
    ds_read_b128 v[60:63], v17 offset:1280
    s_mov_b64 exec, -1
    v_exp_f32 v88, v88
    v_exp_f32 v89, v89
    v_exp_f32 v90, v90
    v_exp_f32 v91, v91
    v_cvt_pk_bf16_f32 v72, v84, v85
    v_cvt_pk_bf16_f32 v73, v86, v87
    v_cvt_pk_bf16_f32 v74, v88, v89
    v_cvt_pk_bf16_f32 v75, v90, v91
    v_mfma_f32_32x32x8_bf16 v[100:115], v[52:53], v[34:35], v[100:115]
    v_exp_f32 v92, v92
    v_exp_f32 v93, v93
    v_exp_f32 v94, v94
    v_exp_f32 v95, v95
    v_mfma_f32_32x32x16_bf16 v[148:163], v[56:59], v[72:75], v[148:163]
    v_exp_f32 v96, v96
    v_exp_f32 v97, v97
    v_exp_f32 v98, v98
    v_exp_f32 v99, v99
    v_cvt_pk_bf16_f32 v76, v92, v93
    v_cvt_pk_bf16_f32 v77, v94, v95
    v_cvt_pk_bf16_f32 v78, v96, v97
    v_cvt_pk_bf16_f32 v79, v98, v99
    s_waitcnt lgkmcnt(0)
    v_mfma_f32_32x32x16_bf16 v[84:99], v[48:51], v[24:27], v[116:131]
    v_exp_f32 v100, v100
    v_exp_f32 v101, v101
    v_exp_f32 v102, v102
    v_exp_f32 v103, v103
    v_mfma_f32_32x32x16_bf16 v[148:163], v[64:67], v[76:79], v[148:163]
    s_add_u32 m0, s44, s29
    s_add_u32 s19, m0, s28
    buffer_load_dwordx4 v2, s[8:11], s19 offen lds
    v_exp_f32 v104, v104
    v_exp_f32 v105, v105
    v_exp_f32 v106, v106
    v_exp_f32 v107, v107
    v_cvt_pk_bf16_f32 v72, v100, v101
    v_cvt_pk_bf16_f32 v73, v102, v103
    v_cvt_pk_bf16_f32 v74, v104, v105
    v_cvt_pk_bf16_f32 v75, v106, v107
    v_mfma_f32_32x32x8_bf16 v[84:99], v[54:55], v[32:33], v[84:99]
    v_exp_f32 v108, v108
    v_exp_f32 v109, v109
    v_exp_f32 v110, v110
    v_exp_f32 v111, v111
    v_mfma_f32_32x32x16_bf16 v[164:179], v[56:59], v[72:75], v[164:179]
    v_exp_f32 v112, v112
    v_exp_f32 v113, v113
    v_exp_f32 v114, v114
    v_exp_f32 v115, v115
    v_cvt_pk_bf16_f32 v76, v108, v109
    v_cvt_pk_bf16_f32 v77, v110, v111
    v_cvt_pk_bf16_f32 v78, v112, v113
    v_cvt_pk_bf16_f32 v79, v114, v115
    v_mfma_f32_32x32x16_bf16 v[100:115], v[48:51], v[28:31], v[132:147]
    ds_read2st64_b64 v[44:47], v5 offset0:5 offset1:6
    ds_read_b64 v[52:53], v7 offset:3584
    v_exp_f32 v84, v84
    v_exp_f32 v85, v85
    v_exp_f32 v86, v86
    v_exp_f32 v87, v87
    v_mfma_f32_32x32x16_bf16 v[164:179], v[64:67], v[76:79], v[164:179]
    s_mov_b64 exec, s[22:23]
    ds_read_b128 v[68:71], v17 offset:1920
    ds_read_b128 v[56:59], v17 offset:2560
    s_mov_b64 exec, -1
    s_add_u32 m0, s44, s49
    s_add_u32 s19, s58, 0
    buffer_load_dwordx4 v2, s[8:11], s19 offen lds
    v_exp_f32 v88, v88
    v_exp_f32 v89, v89
    v_exp_f32 v90, v90
    v_exp_f32 v91, v91
    v_cvt_pk_bf16_f32 v72, v84, v85
    v_cvt_pk_bf16_f32 v73, v86, v87
    v_cvt_pk_bf16_f32 v74, v88, v89
    v_cvt_pk_bf16_f32 v75, v90, v91
    v_mfma_f32_32x32x8_bf16 v[100:115], v[54:55], v[34:35], v[100:115]
    v_exp_f32 v92, v92
    v_exp_f32 v93, v93
    v_exp_f32 v94, v94
    v_exp_f32 v95, v95
    v_mfma_f32_32x32x16_bf16 v[148:163], v[60:63], v[72:75], v[148:163]
    v_exp_f32 v96, v96
    v_exp_f32 v97, v97
    v_exp_f32 v98, v98
    v_exp_f32 v99, v99
    v_cvt_pk_bf16_f32 v76, v92, v93
    v_cvt_pk_bf16_f32 v77, v94, v95
    v_cvt_pk_bf16_f32 v78, v96, v97
    v_cvt_pk_bf16_f32 v79, v98, v99
    s_waitcnt lgkmcnt(0)
    v_mfma_f32_32x32x16_bf16 v[84:99], v[44:47], v[24:27], v[116:131]
    v_exp_f32 v100, v100
    v_exp_f32 v101, v101
    v_exp_f32 v102, v102
    v_exp_f32 v103, v103
    v_mfma_f32_32x32x16_bf16 v[148:163], v[68:71], v[76:79], v[148:163]
    s_add_u32 m0, s45, s29
    s_add_u32 s19, m0, s28
    buffer_load_dwordx4 v2, s[8:11], s19 offen lds
    v_exp_f32 v104, v104
    v_exp_f32 v105, v105
    v_exp_f32 v106, v106
    v_exp_f32 v107, v107
    v_cvt_pk_bf16_f32 v72, v100, v101
    v_cvt_pk_bf16_f32 v73, v102, v103
    v_cvt_pk_bf16_f32 v74, v104, v105
    v_cvt_pk_bf16_f32 v75, v106, v107
    v_mfma_f32_32x32x8_bf16 v[84:99], v[52:53], v[32:33], v[84:99]
    v_exp_f32 v108, v108
    v_exp_f32 v109, v109
    v_exp_f32 v110, v110
    v_exp_f32 v111, v111
    v_mfma_f32_32x32x16_bf16 v[164:179], v[60:63], v[72:75], v[164:179]
    v_exp_f32 v112, v112
    v_exp_f32 v113, v113
    v_exp_f32 v114, v114
    v_exp_f32 v115, v115
    v_cvt_pk_bf16_f32 v76, v108, v109
    v_cvt_pk_bf16_f32 v77, v110, v111
    v_cvt_pk_bf16_f32 v78, v112, v113
    v_cvt_pk_bf16_f32 v79, v114, v115
    v_mfma_f32_32x32x16_bf16 v[100:115], v[44:47], v[28:31], v[132:147]
    ds_read2st64_b64 v[48:51], v6 offset0:5 offset1:6
    ds_read_b64 v[54:55], v7 offset:4864
    v_exp_f32 v84, v84
    v_exp_f32 v85, v85
    v_exp_f32 v86, v86
    v_exp_f32 v87, v87
    v_mfma_f32_32x32x16_bf16 v[164:179], v[68:71], v[76:79], v[164:179]
    s_mov_b64 exec, s[22:23]
    ds_read_b128 v[64:67], v17 offset:3200
    ds_read_b128 v[60:63], v17 offset:3840
    s_mov_b64 exec, -1
    s_add_u32 m0, s45, s49
    s_add_u32 s19, s58, 8192
    buffer_load_dwordx4 v2, s[8:11], s19 offen lds
    v_exp_f32 v88, v88
    v_exp_f32 v89, v89
    v_exp_f32 v90, v90
    v_exp_f32 v91, v91
    v_cvt_pk_bf16_f32 v72, v84, v85
    v_cvt_pk_bf16_f32 v73, v86, v87
    v_cvt_pk_bf16_f32 v74, v88, v89
    v_cvt_pk_bf16_f32 v75, v90, v91
    v_mfma_f32_32x32x8_bf16 v[100:115], v[52:53], v[34:35], v[100:115]
    v_exp_f32 v92, v92
    v_exp_f32 v93, v93
    v_exp_f32 v94, v94
    v_exp_f32 v95, v95
    v_mfma_f32_32x32x16_bf16 v[148:163], v[56:59], v[72:75], v[148:163]
    v_exp_f32 v96, v96
    v_exp_f32 v97, v97
    v_exp_f32 v98, v98
    v_exp_f32 v99, v99
    v_cvt_pk_bf16_f32 v76, v92, v93
    v_cvt_pk_bf16_f32 v77, v94, v95
    v_cvt_pk_bf16_f32 v78, v96, v97
    v_cvt_pk_bf16_f32 v79, v98, v99
    s_waitcnt lgkmcnt(0)
    v_mfma_f32_32x32x16_bf16 v[84:99], v[48:51], v[24:27], v[116:131]
    v_exp_f32 v100, v100
    v_exp_f32 v101, v101
    v_exp_f32 v102, v102
    v_exp_f32 v103, v103
    v_mfma_f32_32x32x16_bf16 v[148:163], v[64:67], v[76:79], v[148:163]
    s_add_u32 m0, s46, s29
    s_add_u32 s19, m0, s28
    buffer_load_dwordx4 v2, s[8:11], s19 offen lds
    v_exp_f32 v104, v104
    v_exp_f32 v105, v105
    v_exp_f32 v106, v106
    v_exp_f32 v107, v107
    v_cvt_pk_bf16_f32 v72, v100, v101
    v_cvt_pk_bf16_f32 v73, v102, v103
    v_cvt_pk_bf16_f32 v74, v104, v105
    v_cvt_pk_bf16_f32 v75, v106, v107
    v_mfma_f32_32x32x8_bf16 v[84:99], v[54:55], v[32:33], v[84:99]
    v_exp_f32 v108, v108
    v_exp_f32 v109, v109
    v_exp_f32 v110, v110
    v_exp_f32 v111, v111
    v_mfma_f32_32x32x16_bf16 v[164:179], v[56:59], v[72:75], v[164:179]
    v_exp_f32 v112, v112
    v_exp_f32 v113, v113
    v_exp_f32 v114, v114
    v_exp_f32 v115, v115
    v_cvt_pk_bf16_f32 v76, v108, v109
    v_cvt_pk_bf16_f32 v77, v110, v111
    v_cvt_pk_bf16_f32 v78, v112, v113
    v_cvt_pk_bf16_f32 v79, v114, v115
    v_mfma_f32_32x32x16_bf16 v[100:115], v[48:51], v[28:31], v[132:147]
    ds_read2st64_b64 v[44:47], v5 offset0:10 offset1:11
    ds_read_b64 v[52:53], v7 offset:6144
    v_exp_f32 v84, v84
    v_exp_f32 v85, v85
    v_exp_f32 v86, v86
    v_exp_f32 v87, v87
    v_mfma_f32_32x32x16_bf16 v[164:179], v[64:67], v[76:79], v[164:179]
    s_mov_b64 exec, s[22:23]
    ds_read_b128 v[68:71], v17 offset:4480
    ds_read_b128 v[56:59], v17 offset:5120
    s_mov_b64 exec, -1
    s_add_u32 m0, s46, s49
    s_add_u32 s19, s58, 16384
    buffer_load_dwordx4 v2, s[8:11], s19 offen lds
    v_exp_f32 v88, v88
    v_exp_f32 v89, v89
    v_exp_f32 v90, v90
    v_exp_f32 v91, v91
    v_cvt_pk_bf16_f32 v72, v84, v85
    v_cvt_pk_bf16_f32 v73, v86, v87
    v_cvt_pk_bf16_f32 v74, v88, v89
    v_cvt_pk_bf16_f32 v75, v90, v91
    v_mfma_f32_32x32x8_bf16 v[100:115], v[54:55], v[34:35], v[100:115]
    v_exp_f32 v92, v92
    v_exp_f32 v93, v93
    v_exp_f32 v94, v94
    v_exp_f32 v95, v95
    v_mfma_f32_32x32x16_bf16 v[148:163], v[60:63], v[72:75], v[148:163]
    v_exp_f32 v96, v96
    v_exp_f32 v97, v97
    v_exp_f32 v98, v98
    v_exp_f32 v99, v99
    v_cvt_pk_bf16_f32 v76, v92, v93
    v_cvt_pk_bf16_f32 v77, v94, v95
    v_cvt_pk_bf16_f32 v78, v96, v97
    v_cvt_pk_bf16_f32 v79, v98, v99
    s_waitcnt lgkmcnt(0)
    v_mfma_f32_32x32x16_bf16 v[84:99], v[44:47], v[24:27], v[116:131]
    v_exp_f32 v100, v100
    v_exp_f32 v101, v101
    v_exp_f32 v102, v102
    v_exp_f32 v103, v103
    v_mfma_f32_32x32x16_bf16 v[148:163], v[68:71], v[76:79], v[148:163]
    s_add_u32 m0, s47, s29
    s_add_u32 s19, m0, s28
    buffer_load_dwordx4 v2, s[8:11], s19 offen lds
    v_exp_f32 v104, v104
    v_exp_f32 v105, v105
    v_exp_f32 v106, v106
    v_exp_f32 v107, v107
    v_cvt_pk_bf16_f32 v72, v100, v101
    v_cvt_pk_bf16_f32 v73, v102, v103
    v_cvt_pk_bf16_f32 v74, v104, v105
    v_cvt_pk_bf16_f32 v75, v106, v107
    v_mfma_f32_32x32x8_bf16 v[84:99], v[52:53], v[32:33], v[84:99]
    v_exp_f32 v108, v108
    v_exp_f32 v109, v109
    v_exp_f32 v110, v110
    v_exp_f32 v111, v111
    v_mfma_f32_32x32x16_bf16 v[164:179], v[60:63], v[72:75], v[164:179]
    v_exp_f32 v112, v112
    v_exp_f32 v113, v113
    v_exp_f32 v114, v114
    v_exp_f32 v115, v115
    v_cvt_pk_bf16_f32 v76, v108, v109
    v_cvt_pk_bf16_f32 v77, v110, v111
    v_cvt_pk_bf16_f32 v78, v112, v113
    v_cvt_pk_bf16_f32 v79, v114, v115
    v_mfma_f32_32x32x16_bf16 v[100:115], v[44:47], v[28:31], v[132:147]
    ds_read2st64_b64 v[48:51], v6 offset0:10 offset1:11
    ds_read_b64 v[54:55], v7 offset:7424
    v_exp_f32 v84, v84
    v_exp_f32 v85, v85
    v_exp_f32 v86, v86
    v_exp_f32 v87, v87
    v_mfma_f32_32x32x16_bf16 v[164:179], v[68:71], v[76:79], v[164:179]
    s_mov_b64 exec, s[22:23]
    ds_read_b128 v[64:67], v17 offset:5760
    ds_read_b128 v[60:63], v17 offset:6400
    s_mov_b64 exec, -1
    s_add_u32 m0, s47, s49
    s_add_u32 s19, s58, 24576
    buffer_load_dwordx4 v2, s[8:11], s19 offen lds
    v_exp_f32 v88, v88
    v_exp_f32 v89, v89
    v_exp_f32 v90, v90
    v_exp_f32 v91, v91
    v_cvt_pk_bf16_f32 v72, v84, v85
    v_cvt_pk_bf16_f32 v73, v86, v87
    v_cvt_pk_bf16_f32 v74, v88, v89
    v_cvt_pk_bf16_f32 v75, v90, v91
    v_mfma_f32_32x32x8_bf16 v[100:115], v[52:53], v[34:35], v[100:115]
    v_exp_f32 v92, v92
    v_exp_f32 v93, v93
    v_exp_f32 v94, v94
    v_exp_f32 v95, v95
    v_mfma_f32_32x32x16_bf16 v[148:163], v[56:59], v[72:75], v[148:163]
    v_exp_f32 v96, v96
    v_exp_f32 v97, v97
    v_exp_f32 v98, v98
    v_exp_f32 v99, v99
    v_cvt_pk_bf16_f32 v76, v92, v93
    v_cvt_pk_bf16_f32 v77, v94, v95
    v_cvt_pk_bf16_f32 v78, v96, v97
    v_cvt_pk_bf16_f32 v79, v98, v99
    s_waitcnt lgkmcnt(0)
    v_mfma_f32_32x32x16_bf16 v[84:99], v[48:51], v[24:27], v[116:131]
    v_exp_f32 v100, v100
    v_exp_f32 v101, v101
    v_exp_f32 v102, v102
    v_exp_f32 v103, v103
    v_mfma_f32_32x32x16_bf16 v[148:163], v[64:67], v[76:79], v[148:163]
    s_add_u32 m0, s48, s29
    s_add_u32 s19, m0, s28
    buffer_load_dwordx4 v2, s[8:11], s19 offen lds
    s_add_u32 s29, s29, 20480
    v_exp_f32 v104, v104
    v_exp_f32 v105, v105
    v_exp_f32 v106, v106
    v_exp_f32 v107, v107
    v_cvt_pk_bf16_f32 v72, v100, v101
    v_cvt_pk_bf16_f32 v73, v102, v103
    v_cvt_pk_bf16_f32 v74, v104, v105
    v_cvt_pk_bf16_f32 v75, v106, v107
    v_mfma_f32_32x32x8_bf16 v[84:99], v[54:55], v[32:33], v[84:99]
    v_exp_f32 v108, v108
    v_exp_f32 v109, v109
    v_exp_f32 v110, v110
    v_exp_f32 v111, v111
    v_mfma_f32_32x32x16_bf16 v[164:179], v[56:59], v[72:75], v[164:179]
    v_exp_f32 v112, v112
    v_exp_f32 v113, v113
    v_exp_f32 v114, v114
    v_exp_f32 v115, v115
    v_cvt_pk_bf16_f32 v76, v108, v109
    v_cvt_pk_bf16_f32 v77, v110, v111
    v_cvt_pk_bf16_f32 v78, v112, v113
    v_cvt_pk_bf16_f32 v79, v114, v115
    v_mfma_f32_32x32x16_bf16 v[100:115], v[48:51], v[28:31], v[132:147]
    ds_read2st64_b64 v[44:47], v5 offset0:15 offset1:16
    ds_read_b64 v[52:53], v7 offset:8704
    v_exp_f32 v84, v84
    v_exp_f32 v85, v85
    v_exp_f32 v86, v86
    v_exp_f32 v87, v87
    v_mfma_f32_32x32x16_bf16 v[164:179], v[64:67], v[76:79], v[164:179]
    s_mov_b64 exec, s[22:23]
    ds_read_b128 v[68:71], v17 offset:7040
    ds_read_b128 v[56:59], v17 offset:7680
    s_mov_b64 exec, -1
    s_add_u32 m0, s48, s49
    s_add_u32 s19, s58, 32768
    buffer_load_dwordx4 v2, s[8:11], s19 offen lds
    s_add_u32 s49, s49, 20480
    s_add_u32 s58, s58, 40960
    v_exp_f32 v88, v88
    v_exp_f32 v89, v89
    v_exp_f32 v90, v90
    v_exp_f32 v91, v91
    v_cvt_pk_bf16_f32 v72, v84, v85
    v_cvt_pk_bf16_f32 v73, v86, v87
    v_cvt_pk_bf16_f32 v74, v88, v89
    v_cvt_pk_bf16_f32 v75, v90, v91
    v_mfma_f32_32x32x8_bf16 v[100:115], v[54:55], v[34:35], v[100:115]
    v_exp_f32 v92, v92
    v_exp_f32 v93, v93
    v_exp_f32 v94, v94
    v_exp_f32 v95, v95
    v_mfma_f32_32x32x16_bf16 v[148:163], v[60:63], v[72:75], v[148:163]
    v_exp_f32 v96, v96
    v_exp_f32 v97, v97
    v_exp_f32 v98, v98
    v_exp_f32 v99, v99
    v_cvt_pk_bf16_f32 v76, v92, v93
    v_cvt_pk_bf16_f32 v77, v94, v95
    v_cvt_pk_bf16_f32 v78, v96, v97
    v_cvt_pk_bf16_f32 v79, v98, v99
    s_waitcnt lgkmcnt(0)
    v_mfma_f32_32x32x16_bf16 v[84:99], v[44:47], v[24:27], v[116:131]
    v_exp_f32 v100, v100
    v_exp_f32 v101, v101
    v_exp_f32 v102, v102
    v_exp_f32 v103, v103
    v_mfma_f32_32x32x16_bf16 v[148:163], v[68:71], v[76:79], v[148:163]
    v_exp_f32 v104, v104
    v_exp_f32 v105, v105
    v_exp_f32 v106, v106
    v_exp_f32 v107, v107
    v_cvt_pk_bf16_f32 v72, v100, v101
    v_cvt_pk_bf16_f32 v73, v102, v103
    v_cvt_pk_bf16_f32 v74, v104, v105
    v_cvt_pk_bf16_f32 v75, v106, v107
    v_mfma_f32_32x32x8_bf16 v[84:99], v[52:53], v[32:33], v[84:99]
    v_exp_f32 v108, v108
    v_exp_f32 v109, v109
    v_exp_f32 v110, v110
    v_exp_f32 v111, v111
    v_mfma_f32_32x32x16_bf16 v[164:179], v[60:63], v[72:75], v[164:179]
    v_exp_f32 v112, v112
    v_exp_f32 v113, v113
    v_exp_f32 v114, v114
    v_exp_f32 v115, v115
    v_cvt_pk_bf16_f32 v76, v108, v109
    v_cvt_pk_bf16_f32 v77, v110, v111
    v_cvt_pk_bf16_f32 v78, v112, v113
    v_cvt_pk_bf16_f32 v79, v114, v115
    s_setprio 0
    v_mfma_f32_32x32x16_bf16 v[100:115], v[44:47], v[28:31], v[132:147]
    ds_read2st64_b64 v[48:51], v6 offset0:15 offset1:16
    ds_read_b64 v[54:55], v7 offset:9984
    v_exp_f32 v84, v84
    v_exp_f32 v85, v85
    v_exp_f32 v86, v86
    v_exp_f32 v87, v87
    v_mfma_f32_32x32x16_bf16 v[164:179], v[68:71], v[76:79], v[164:179]
    s_mov_b64 exec, s[22:23]
    ds_read_b128 v[64:67], v17 offset:8320
    ds_read_b128 v[60:63], v17 offset:8960
    s_mov_b64 exec, -1
    v_exp_f32 v88, v88
    v_exp_f32 v89, v89
    v_exp_f32 v90, v90
    v_exp_f32 v91, v91
    v_cvt_pk_bf16_f32 v72, v84, v85
    v_cvt_pk_bf16_f32 v73, v86, v87
    v_cvt_pk_bf16_f32 v74, v88, v89
    v_cvt_pk_bf16_f32 v75, v90, v91
    v_mfma_f32_32x32x8_bf16 v[100:115], v[52:53], v[34:35], v[100:115]
    v_exp_f32 v92, v92
    v_exp_f32 v93, v93
    v_exp_f32 v94, v94
    v_exp_f32 v95, v95
    v_mfma_f32_32x32x16_bf16 v[148:163], v[56:59], v[72:75], v[148:163]
    v_exp_f32 v96, v96
    v_exp_f32 v97, v97
    v_exp_f32 v98, v98
    v_exp_f32 v99, v99
    v_cvt_pk_bf16_f32 v76, v92, v93
    v_cvt_pk_bf16_f32 v77, v94, v95
    v_cvt_pk_bf16_f32 v78, v96, v97
    v_cvt_pk_bf16_f32 v79, v98, v99
    s_waitcnt lgkmcnt(0)
    v_mfma_f32_32x32x16_bf16 v[84:99], v[48:51], v[24:27], v[116:131]
    v_exp_f32 v100, v100
    v_exp_f32 v101, v101
    v_exp_f32 v102, v102
    v_exp_f32 v103, v103
    v_mfma_f32_32x32x16_bf16 v[148:163], v[64:67], v[76:79], v[148:163]
    v_exp_f32 v104, v104
    v_exp_f32 v105, v105
    v_exp_f32 v106, v106
    v_exp_f32 v107, v107
    v_cvt_pk_bf16_f32 v72, v100, v101
    v_cvt_pk_bf16_f32 v73, v102, v103
    v_cvt_pk_bf16_f32 v74, v104, v105
    v_cvt_pk_bf16_f32 v75, v106, v107
    v_mfma_f32_32x32x8_bf16 v[84:99], v[54:55], v[32:33], v[84:99]
    v_exp_f32 v108, v108
    v_exp_f32 v109, v109
    v_exp_f32 v110, v110
    v_exp_f32 v111, v111
    v_mfma_f32_32x32x16_bf16 v[164:179], v[56:59], v[72:75], v[164:179]
    v_exp_f32 v112, v112
    v_exp_f32 v113, v113
    v_exp_f32 v114, v114
    v_exp_f32 v115, v115
    v_cvt_pk_bf16_f32 v76, v108, v109
    v_cvt_pk_bf16_f32 v77, v110, v111
    v_cvt_pk_bf16_f32 v78, v112, v113
    v_cvt_pk_bf16_f32 v79, v114, v115
    s_waitcnt vmcnt(0)
    s_barrier
    s_setprio 2
    v_mfma_f32_32x32x16_bf16 v[100:115], v[48:51], v[28:31], v[132:147]
    ds_read2st64_b64 v[44:47], v5 offset0:40 offset1:41
    ds_read_b64 v[52:53], v7 offset:21504
    v_exp_f32 v84, v84
    v_exp_f32 v85, v85
    v_exp_f32 v86, v86
    v_exp_f32 v87, v87
    v_mfma_f32_32x32x16_bf16 v[164:179], v[64:67], v[76:79], v[164:179]
    s_mov_b64 exec, s[22:23]
    ds_read_b128 v[68:71], v17 offset:9600
    ds_read_b128 v[56:59], v17 offset:20480
    s_mov_b64 exec, -1
    v_exp_f32 v88, v88
    v_exp_f32 v89, v89
    v_exp_f32 v90, v90
    v_exp_f32 v91, v91
    v_cvt_pk_bf16_f32 v72, v84, v85
    v_cvt_pk_bf16_f32 v73, v86, v87
    v_cvt_pk_bf16_f32 v74, v88, v89
    v_cvt_pk_bf16_f32 v75, v90, v91
    v_mfma_f32_32x32x8_bf16 v[100:115], v[54:55], v[34:35], v[100:115]
    v_exp_f32 v92, v92
    v_exp_f32 v93, v93
    v_exp_f32 v94, v94
    v_exp_f32 v95, v95
    v_mfma_f32_32x32x16_bf16 v[148:163], v[60:63], v[72:75], v[148:163]
    v_exp_f32 v96, v96
    v_exp_f32 v97, v97
    v_exp_f32 v98, v98
    v_exp_f32 v99, v99
    v_cvt_pk_bf16_f32 v76, v92, v93
    v_cvt_pk_bf16_f32 v77, v94, v95
    v_cvt_pk_bf16_f32 v78, v96, v97
    v_cvt_pk_bf16_f32 v79, v98, v99
    s_waitcnt lgkmcnt(0)
    v_mfma_f32_32x32x16_bf16 v[84:99], v[44:47], v[24:27], v[116:131]
    v_exp_f32 v100, v100
    v_exp_f32 v101, v101
    v_exp_f32 v102, v102
    v_exp_f32 v103, v103
    v_mfma_f32_32x32x16_bf16 v[148:163], v[68:71], v[76:79], v[148:163]
    v_exp_f32 v104, v104
    v_exp_f32 v105, v105
    v_exp_f32 v106, v106
    v_exp_f32 v107, v107
    v_cvt_pk_bf16_f32 v72, v100, v101
    v_cvt_pk_bf16_f32 v73, v102, v103
    v_cvt_pk_bf16_f32 v74, v104, v105
    v_cvt_pk_bf16_f32 v75, v106, v107
    v_mfma_f32_32x32x8_bf16 v[84:99], v[52:53], v[32:33], v[84:99]
    v_exp_f32 v108, v108
    v_exp_f32 v109, v109
    v_exp_f32 v110, v110
    v_exp_f32 v111, v111
    v_mfma_f32_32x32x16_bf16 v[164:179], v[60:63], v[72:75], v[164:179]
    v_exp_f32 v112, v112
    v_exp_f32 v113, v113
    v_exp_f32 v114, v114
    v_exp_f32 v115, v115
    v_cvt_pk_bf16_f32 v76, v108, v109
    v_cvt_pk_bf16_f32 v77, v110, v111
    v_cvt_pk_bf16_f32 v78, v112, v113
    v_cvt_pk_bf16_f32 v79, v114, v115
    v_add_u32 v5, 20480, v5
    v_add_u32 v6, 20480, v6
    v_add_u32 v7, 20480, v7
    v_add_u32 v17, 20480, v17
    v_mfma_f32_32x32x16_bf16 v[100:115], v[44:47], v[28:31], v[132:147]
    ds_read2st64_b64 v[48:51], v6 offset0:0 offset1:1
    ds_read_b64 v[54:55], v7 offset:2304
    v_exp_f32 v84, v84
    v_exp_f32 v85, v85
    v_exp_f32 v86, v86
    v_exp_f32 v87, v87
    v_mfma_f32_32x32x16_bf16 v[164:179], v[68:71], v[76:79], v[164:179]
    s_mov_b64 exec, s[22:23]
    ds_read_b128 v[64:67], v17 offset:640
    ds_read_b128 v[60:63], v17 offset:1280
    s_mov_b64 exec, -1
    v_exp_f32 v88, v88
    v_exp_f32 v89, v89
    v_exp_f32 v90, v90
    v_exp_f32 v91, v91
    v_cvt_pk_bf16_f32 v72, v84, v85
    v_cvt_pk_bf16_f32 v73, v86, v87
    v_cvt_pk_bf16_f32 v74, v88, v89
    v_cvt_pk_bf16_f32 v75, v90, v91
    v_mfma_f32_32x32x8_bf16 v[100:115], v[52:53], v[34:35], v[100:115]
    v_exp_f32 v92, v92
    v_exp_f32 v93, v93
    v_exp_f32 v94, v94
    v_exp_f32 v95, v95
    v_mfma_f32_32x32x16_bf16 v[148:163], v[56:59], v[72:75], v[148:163]
    v_exp_f32 v96, v96
    v_exp_f32 v97, v97
    v_exp_f32 v98, v98
    v_exp_f32 v99, v99
    v_cvt_pk_bf16_f32 v76, v92, v93
    v_cvt_pk_bf16_f32 v77, v94, v95
    v_cvt_pk_bf16_f32 v78, v96, v97
    v_cvt_pk_bf16_f32 v79, v98, v99
    s_waitcnt lgkmcnt(0)
    v_mfma_f32_32x32x16_bf16 v[84:99], v[48:51], v[24:27], v[116:131]
    v_exp_f32 v100, v100
    v_exp_f32 v101, v101
    v_exp_f32 v102, v102
    v_exp_f32 v103, v103
    v_mfma_f32_32x32x16_bf16 v[148:163], v[64:67], v[76:79], v[148:163]
    buffer_load_dwordx2 v[36:37], v23, s[8:11], s33 offen offset:0
    buffer_load_dwordx2 v[38:39], v23, s[8:11], s33 offen offset:512
    buffer_load_dwordx2 v[40:41], v3, s[8:11], s33 offen offset:1024
    v_exp_f32 v104, v104
    v_exp_f32 v105, v105
    v_exp_f32 v106, v106
    v_exp_f32 v107, v107
    v_cvt_pk_bf16_f32 v72, v100, v101
    v_cvt_pk_bf16_f32 v73, v102, v103
    v_cvt_pk_bf16_f32 v74, v104, v105
    v_cvt_pk_bf16_f32 v75, v106, v107
    v_mfma_f32_32x32x8_bf16 v[84:99], v[54:55], v[32:33], v[84:99]
    v_exp_f32 v108, v108
    v_exp_f32 v109, v109
    v_exp_f32 v110, v110
    v_exp_f32 v111, v111
    v_mfma_f32_32x32x16_bf16 v[164:179], v[56:59], v[72:75], v[164:179]
    v_exp_f32 v112, v112
    v_exp_f32 v113, v113
    v_exp_f32 v114, v114
    v_exp_f32 v115, v115
    v_cvt_pk_bf16_f32 v76, v108, v109
    v_cvt_pk_bf16_f32 v77, v110, v111
    v_cvt_pk_bf16_f32 v78, v112, v113
    v_cvt_pk_bf16_f32 v79, v114, v115
    v_mfma_f32_32x32x16_bf16 v[100:115], v[48:51], v[28:31], v[132:147]
    ds_read2st64_b64 v[44:47], v5 offset0:5 offset1:6
    ds_read_b64 v[52:53], v7 offset:3584
    v_exp_f32 v84, v84
    v_exp_f32 v85, v85
    v_exp_f32 v86, v86
    v_exp_f32 v87, v87
    v_mfma_f32_32x32x16_bf16 v[164:179], v[64:67], v[76:79], v[164:179]
    s_mov_b64 exec, s[22:23]
    ds_read_b128 v[68:71], v17 offset:1920
    ds_read_b128 v[56:59], v17 offset:2560
    s_mov_b64 exec, -1
    s_add_u32 m0, s44, s49
    s_add_u32 s19, s58, 0
    buffer_load_dwordx4 v2, s[8:11], s19 offen lds
    v_exp_f32 v88, v88
    v_exp_f32 v89, v89
    v_exp_f32 v90, v90
    v_exp_f32 v91, v91
    v_cvt_pk_bf16_f32 v72, v84, v85
    v_cvt_pk_bf16_f32 v73, v86, v87
    v_cvt_pk_bf16_f32 v74, v88, v89
    v_cvt_pk_bf16_f32 v75, v90, v91
    v_mfma_f32_32x32x8_bf16 v[100:115], v[54:55], v[34:35], v[100:115]
    v_exp_f32 v92, v92
    v_exp_f32 v93, v93
    v_exp_f32 v94, v94
    v_exp_f32 v95, v95
    v_mfma_f32_32x32x16_bf16 v[148:163], v[60:63], v[72:75], v[148:163]
    v_exp_f32 v96, v96
    v_exp_f32 v97, v97
    v_exp_f32 v98, v98
    v_exp_f32 v99, v99
    v_cvt_pk_bf16_f32 v76, v92, v93
    v_cvt_pk_bf16_f32 v77, v94, v95
    v_cvt_pk_bf16_f32 v78, v96, v97
    v_cvt_pk_bf16_f32 v79, v98, v99
    s_waitcnt lgkmcnt(0)
    v_mfma_f32_32x32x16_bf16 v[84:99], v[44:47], v[24:27], v[116:131]
    v_exp_f32 v100, v100
    v_exp_f32 v101, v101
    v_exp_f32 v102, v102
    v_exp_f32 v103, v103
    v_mfma_f32_32x32x16_bf16 v[148:163], v[68:71], v[76:79], v[148:163]
    buffer_load_dwordx2 v[180:181], v18, s[8:11], 0 offen
    buffer_load_dwordx2 v[182:183], v18, s[8:11], 0 offen offset:512
    buffer_load_dwordx2 v[188:189], v19, s[8:11], 0 offen offset:1024
    v_exp_f32 v104, v104
    v_exp_f32 v105, v105
    v_exp_f32 v106, v106
    v_exp_f32 v107, v107
    v_cvt_pk_bf16_f32 v72, v100, v101
    v_cvt_pk_bf16_f32 v73, v102, v103
    v_cvt_pk_bf16_f32 v74, v104, v105
    v_cvt_pk_bf16_f32 v75, v106, v107
    v_mfma_f32_32x32x8_bf16 v[84:99], v[52:53], v[32:33], v[84:99]
    v_exp_f32 v108, v108
    v_exp_f32 v109, v109
    v_exp_f32 v110, v110
    v_exp_f32 v111, v111
    v_mfma_f32_32x32x16_bf16 v[164:179], v[60:63], v[72:75], v[164:179]
    v_exp_f32 v112, v112
    v_exp_f32 v113, v113
    v_exp_f32 v114, v114
    v_exp_f32 v115, v115
    v_cvt_pk_bf16_f32 v76, v108, v109
    v_cvt_pk_bf16_f32 v77, v110, v111
    v_cvt_pk_bf16_f32 v78, v112, v113
    v_cvt_pk_bf16_f32 v79, v114, v115
    v_mfma_f32_32x32x16_bf16 v[100:115], v[44:47], v[28:31], v[132:147]
    ds_read2st64_b64 v[48:51], v6 offset0:5 offset1:6
    ds_read_b64 v[54:55], v7 offset:4864
    v_exp_f32 v84, v84
    v_exp_f32 v85, v85
    v_exp_f32 v86, v86
    v_exp_f32 v87, v87
    v_mfma_f32_32x32x16_bf16 v[164:179], v[68:71], v[76:79], v[164:179]
    s_mov_b64 exec, s[22:23]
    ds_read_b128 v[64:67], v17 offset:3200
    ds_read_b128 v[60:63], v17 offset:3840
    s_mov_b64 exec, -1
    s_add_u32 m0, s45, s49
    s_add_u32 s19, s58, 8192
    buffer_load_dwordx4 v2, s[8:11], s19 offen lds
    v_exp_f32 v88, v88
    v_exp_f32 v89, v89
    v_exp_f32 v90, v90
    v_exp_f32 v91, v91
    v_cvt_pk_bf16_f32 v72, v84, v85
    v_cvt_pk_bf16_f32 v73, v86, v87
    v_cvt_pk_bf16_f32 v74, v88, v89
    v_cvt_pk_bf16_f32 v75, v90, v91
    v_mfma_f32_32x32x8_bf16 v[100:115], v[52:53], v[34:35], v[100:115]
    v_exp_f32 v92, v92
    v_exp_f32 v93, v93
    v_exp_f32 v94, v94
    v_exp_f32 v95, v95
    v_mfma_f32_32x32x16_bf16 v[148:163], v[56:59], v[72:75], v[148:163]
    v_exp_f32 v96, v96
    v_exp_f32 v97, v97
    v_exp_f32 v98, v98
    v_exp_f32 v99, v99
    v_cvt_pk_bf16_f32 v76, v92, v93
    v_cvt_pk_bf16_f32 v77, v94, v95
    v_cvt_pk_bf16_f32 v78, v96, v97
    v_cvt_pk_bf16_f32 v79, v98, v99
    s_waitcnt lgkmcnt(0)
    v_mfma_f32_32x32x16_bf16 v[84:99], v[48:51], v[24:27], v[116:131]
    v_exp_f32 v100, v100
    v_exp_f32 v101, v101
    v_exp_f32 v102, v102
    v_exp_f32 v103, v103
    v_mfma_f32_32x32x16_bf16 v[148:163], v[64:67], v[76:79], v[148:163]
    buffer_load_dwordx2 v[184:185], v20, s[8:11], 0 offen
    buffer_load_dwordx2 v[186:187], v20, s[8:11], 0 offen offset:512
    buffer_load_dwordx2 v[190:191], v21, s[8:11], 0 offen offset:1024
    v_exp_f32 v104, v104
    v_exp_f32 v105, v105
    v_exp_f32 v106, v106
    v_exp_f32 v107, v107
    v_cvt_pk_bf16_f32 v72, v100, v101
    v_cvt_pk_bf16_f32 v73, v102, v103
    v_cvt_pk_bf16_f32 v74, v104, v105
    v_cvt_pk_bf16_f32 v75, v106, v107
    v_mfma_f32_32x32x8_bf16 v[84:99], v[54:55], v[32:33], v[84:99]
    v_exp_f32 v108, v108
    v_exp_f32 v109, v109
    v_exp_f32 v110, v110
    v_exp_f32 v111, v111
    v_mfma_f32_32x32x16_bf16 v[164:179], v[56:59], v[72:75], v[164:179]
    v_exp_f32 v112, v112
    v_exp_f32 v113, v113
    v_exp_f32 v114, v114
    v_exp_f32 v115, v115
    v_cvt_pk_bf16_f32 v76, v108, v109
    v_cvt_pk_bf16_f32 v77, v110, v111
    v_cvt_pk_bf16_f32 v78, v112, v113
    v_cvt_pk_bf16_f32 v79, v114, v115
    v_mfma_f32_32x32x16_bf16 v[100:115], v[48:51], v[28:31], v[132:147]
    ds_read2st64_b64 v[44:47], v5 offset0:10 offset1:11
    ds_read_b64 v[52:53], v7 offset:6144
    v_exp_f32 v84, v84
    v_exp_f32 v85, v85
    v_exp_f32 v86, v86
    v_exp_f32 v87, v87
    v_mfma_f32_32x32x16_bf16 v[164:179], v[64:67], v[76:79], v[164:179]
    s_mov_b64 exec, s[22:23]
    ds_read_b128 v[68:71], v17 offset:4480
    ds_read_b128 v[56:59], v17 offset:5120
    s_mov_b64 exec, -1
    s_add_u32 m0, s46, s49
    s_add_u32 s19, s58, 16384
    buffer_load_dwordx4 v2, s[8:11], s19 offen lds
    v_exp_f32 v88, v88
    v_exp_f32 v89, v89
    v_exp_f32 v90, v90
    v_exp_f32 v91, v91
    v_cvt_pk_bf16_f32 v72, v84, v85
    v_cvt_pk_bf16_f32 v73, v86, v87
    v_cvt_pk_bf16_f32 v74, v88, v89
    v_cvt_pk_bf16_f32 v75, v90, v91
    v_mfma_f32_32x32x8_bf16 v[100:115], v[54:55], v[34:35], v[100:115]
    v_exp_f32 v92, v92
    v_exp_f32 v93, v93
    v_exp_f32 v94, v94
    v_exp_f32 v95, v95
    v_mfma_f32_32x32x16_bf16 v[148:163], v[60:63], v[72:75], v[148:163]
    v_exp_f32 v96, v96
    v_exp_f32 v97, v97
    v_exp_f32 v98, v98
    v_exp_f32 v99, v99
    v_cvt_pk_bf16_f32 v76, v92, v93
    v_cvt_pk_bf16_f32 v77, v94, v95
    v_cvt_pk_bf16_f32 v78, v96, v97
    v_cvt_pk_bf16_f32 v79, v98, v99
    s_waitcnt lgkmcnt(0)
    v_mfma_f32_32x32x16_bf16 v[84:99], v[44:47], v[24:27], v[116:131]
    v_exp_f32 v100, v100
    v_exp_f32 v101, v101
    v_exp_f32 v102, v102
    v_exp_f32 v103, v103
    v_mfma_f32_32x32x16_bf16 v[148:163], v[68:71], v[76:79], v[148:163]
    s_mov_b64 exec, s[22:23]
    buffer_load_dwordx4 v[192:195], v4, s[8:11], s30 offen
    buffer_load_dwordx4 v[196:199], v4, s[8:11], s31 offen
    buffer_load_dwordx4 v[200:203], v4, s[8:11], s32 offen
    s_mov_b64 exec, -1
    v_exp_f32 v104, v104
    v_exp_f32 v105, v105
    v_exp_f32 v106, v106
    v_exp_f32 v107, v107
    v_cvt_pk_bf16_f32 v72, v100, v101
    v_cvt_pk_bf16_f32 v73, v102, v103
    v_cvt_pk_bf16_f32 v74, v104, v105
    v_cvt_pk_bf16_f32 v75, v106, v107
    v_mfma_f32_32x32x8_bf16 v[84:99], v[52:53], v[32:33], v[84:99]
    v_exp_f32 v108, v108
    v_exp_f32 v109, v109
    v_exp_f32 v110, v110
    v_exp_f32 v111, v111
    v_mfma_f32_32x32x16_bf16 v[164:179], v[60:63], v[72:75], v[164:179]
    v_exp_f32 v112, v112
    v_exp_f32 v113, v113
    v_exp_f32 v114, v114
    v_exp_f32 v115, v115
    v_cvt_pk_bf16_f32 v76, v108, v109
    v_cvt_pk_bf16_f32 v77, v110, v111
    v_cvt_pk_bf16_f32 v78, v112, v113
    v_cvt_pk_bf16_f32 v79, v114, v115
    v_mfma_f32_32x32x16_bf16 v[100:115], v[44:47], v[28:31], v[132:147]
    ds_read2st64_b64 v[48:51], v6 offset0:10 offset1:11
    ds_read_b64 v[54:55], v7 offset:7424
    v_exp_f32 v84, v84
    v_exp_f32 v85, v85
    v_exp_f32 v86, v86
    v_exp_f32 v87, v87
    v_mfma_f32_32x32x16_bf16 v[164:179], v[68:71], v[76:79], v[164:179]
    s_mov_b64 exec, s[22:23]
    ds_read_b128 v[64:67], v17 offset:5760
    ds_read_b128 v[60:63], v17 offset:6400
    s_mov_b64 exec, -1
    s_add_u32 m0, s47, s49
    s_add_u32 s19, s58, 24576
    buffer_load_dwordx4 v2, s[8:11], s19 offen lds
    v_exp_f32 v88, v88
    v_exp_f32 v89, v89
    v_exp_f32 v90, v90
    v_exp_f32 v91, v91
    v_cvt_pk_bf16_f32 v72, v84, v85
    v_cvt_pk_bf16_f32 v73, v86, v87
    v_cvt_pk_bf16_f32 v74, v88, v89
    v_cvt_pk_bf16_f32 v75, v90, v91
    v_mfma_f32_32x32x8_bf16 v[100:115], v[52:53], v[34:35], v[100:115]
    v_exp_f32 v92, v92
    v_exp_f32 v93, v93
    v_exp_f32 v94, v94
    v_exp_f32 v95, v95
    v_mfma_f32_32x32x16_bf16 v[148:163], v[56:59], v[72:75], v[148:163]
    v_exp_f32 v96, v96
    v_exp_f32 v97, v97
    v_exp_f32 v98, v98
    v_exp_f32 v99, v99
    v_cvt_pk_bf16_f32 v76, v92, v93
    v_cvt_pk_bf16_f32 v77, v94, v95
    v_cvt_pk_bf16_f32 v78, v96, v97
    v_cvt_pk_bf16_f32 v79, v98, v99
    s_waitcnt lgkmcnt(0)
    v_mfma_f32_32x32x16_bf16 v[84:99], v[48:51], v[24:27], v[116:131]
    v_exp_f32 v100, v100
    v_exp_f32 v101, v101
    v_exp_f32 v102, v102
    v_exp_f32 v103, v103
    v_mfma_f32_32x32x16_bf16 v[148:163], v[64:67], v[76:79], v[148:163]
    global_load_dwordx4 v[204:207], v2, s[56:57] offset:0
    global_load_dwordx4 v[208:211], v2, s[56:57] offset:1024
    global_load_dwordx4 v[212:215], v2, s[56:57] offset:2048
    global_load_dwordx4 v[216:219], v2, s[56:57] offset:3072
    v_add_u32 v15, 4096, v2
    global_load_dwordx4 v[220:223], v15, s[56:57] offset:0
    global_load_dwordx4 v[224:227], v15, s[56:57] offset:1024
    v_lshrrev_b32 v15, 1, v3
    buffer_load_dword v16, v15, s[8:11], s35 offen
    v_exp_f32 v104, v104
    v_exp_f32 v105, v105
    v_exp_f32 v106, v106
    v_exp_f32 v107, v107
    v_cvt_pk_bf16_f32 v72, v100, v101
    v_cvt_pk_bf16_f32 v73, v102, v103
    v_cvt_pk_bf16_f32 v74, v104, v105
    v_cvt_pk_bf16_f32 v75, v106, v107
    v_mfma_f32_32x32x8_bf16 v[84:99], v[54:55], v[32:33], v[84:99]
    v_exp_f32 v108, v108
    v_exp_f32 v109, v109
    v_exp_f32 v110, v110
    v_exp_f32 v111, v111
    v_mfma_f32_32x32x16_bf16 v[164:179], v[56:59], v[72:75], v[164:179]
    v_exp_f32 v112, v112
    v_exp_f32 v113, v113
    v_exp_f32 v114, v114
    v_exp_f32 v115, v115
    v_cvt_pk_bf16_f32 v76, v108, v109
    v_cvt_pk_bf16_f32 v77, v110, v111
    v_cvt_pk_bf16_f32 v78, v112, v113
    v_cvt_pk_bf16_f32 v79, v114, v115
    v_mfma_f32_32x32x16_bf16 v[100:115], v[48:51], v[28:31], v[132:147]
    ds_read2st64_b64 v[44:47], v5 offset0:15 offset1:16
    ds_read_b64 v[52:53], v7 offset:8704
    v_exp_f32 v84, v84
    v_exp_f32 v85, v85
    v_exp_f32 v86, v86
    v_exp_f32 v87, v87
    v_mfma_f32_32x32x16_bf16 v[164:179], v[64:67], v[76:79], v[164:179]
    s_mov_b64 exec, s[22:23]
    ds_read_b128 v[68:71], v17 offset:7040
    ds_read_b128 v[56:59], v17 offset:7680
    s_mov_b64 exec, -1
    s_add_u32 m0, s48, s49
    s_add_u32 s19, s58, 32768
    buffer_load_dwordx4 v2, s[8:11], s19 offen lds
    s_add_u32 s49, s49, 20480
    s_add_u32 s58, s58, 40960
    v_exp_f32 v88, v88
    v_exp_f32 v89, v89
    v_exp_f32 v90, v90
    v_exp_f32 v91, v91
    v_cvt_pk_bf16_f32 v72, v84, v85
    v_cvt_pk_bf16_f32 v73, v86, v87
    v_cvt_pk_bf16_f32 v74, v88, v89
    v_cvt_pk_bf16_f32 v75, v90, v91
    v_mfma_f32_32x32x8_bf16 v[100:115], v[54:55], v[34:35], v[100:115]
    v_exp_f32 v92, v92
    v_exp_f32 v93, v93
    v_exp_f32 v94, v94
    v_exp_f32 v95, v95
    v_mfma_f32_32x32x16_bf16 v[148:163], v[60:63], v[72:75], v[148:163]
    v_exp_f32 v96, v96
    v_exp_f32 v97, v97
    v_exp_f32 v98, v98
    v_exp_f32 v99, v99
    v_cvt_pk_bf16_f32 v76, v92, v93
    v_cvt_pk_bf16_f32 v77, v94, v95
    v_cvt_pk_bf16_f32 v78, v96, v97
    v_cvt_pk_bf16_f32 v79, v98, v99
    s_waitcnt lgkmcnt(0)
    v_mfma_f32_32x32x16_bf16 v[84:99], v[44:47], v[24:27], v[116:131]
    v_exp_f32 v100, v100
    v_exp_f32 v101, v101
    v_exp_f32 v102, v102
    v_exp_f32 v103, v103
    v_mfma_f32_32x32x16_bf16 v[148:163], v[68:71], v[76:79], v[148:163]
    v_exp_f32 v104, v104
    v_exp_f32 v105, v105
    v_exp_f32 v106, v106
    v_exp_f32 v107, v107
    v_cvt_pk_bf16_f32 v72, v100, v101
    v_cvt_pk_bf16_f32 v73, v102, v103
    v_cvt_pk_bf16_f32 v74, v104, v105
    v_cvt_pk_bf16_f32 v75, v106, v107
    v_mfma_f32_32x32x8_bf16 v[84:99], v[52:53], v[32:33], v[84:99]
    v_exp_f32 v108, v108
    v_exp_f32 v109, v109
    v_exp_f32 v110, v110
    v_exp_f32 v111, v111
    v_mfma_f32_32x32x16_bf16 v[164:179], v[60:63], v[72:75], v[164:179]
    v_exp_f32 v112, v112
    v_exp_f32 v113, v113
    v_exp_f32 v114, v114
    v_exp_f32 v115, v115
    v_cvt_pk_bf16_f32 v76, v108, v109
    v_cvt_pk_bf16_f32 v77, v110, v111
    v_cvt_pk_bf16_f32 v78, v112, v113
    v_cvt_pk_bf16_f32 v79, v114, v115
    s_cmp_lg_u32 s26, 0
    s_cbranch_scc1 K2_KEEPP
    s_setprio 0
K2_KEEPP:
    v_mfma_f32_32x32x16_bf16 v[100:115], v[44:47], v[28:31], v[132:147]
    ds_read2st64_b64 v[48:51], v6 offset0:15 offset1:16
    ds_read_b64 v[54:55], v7 offset:9984
    v_exp_f32 v84, v84
    v_exp_f32 v85, v85
    v_exp_f32 v86, v86
    v_exp_f32 v87, v87
    v_mfma_f32_32x32x16_bf16 v[164:179], v[68:71], v[76:79], v[164:179]
    s_mov_b64 exec, s[22:23]
    ds_read_b128 v[64:67], v17 offset:8320
    ds_read_b128 v[60:63], v17 offset:8960
    s_mov_b64 exec, -1
    v_exp_f32 v88, v88
    v_exp_f32 v89, v89
    v_exp_f32 v90, v90
    v_exp_f32 v91, v91
    v_cvt_pk_bf16_f32 v72, v84, v85
    v_cvt_pk_bf16_f32 v73, v86, v87
    v_cvt_pk_bf16_f32 v74, v88, v89
    v_cvt_pk_bf16_f32 v75, v90, v91
    v_mfma_f32_32x32x8_bf16 v[100:115], v[52:53], v[34:35], v[100:115]
    v_exp_f32 v92, v92
    v_exp_f32 v93, v93
    v_exp_f32 v94, v94
    v_exp_f32 v95, v95
    v_mfma_f32_32x32x16_bf16 v[148:163], v[56:59], v[72:75], v[148:163]
    v_exp_f32 v96, v96
    v_exp_f32 v97, v97
    v_exp_f32 v98, v98
    v_exp_f32 v99, v99
    v_cvt_pk_bf16_f32 v76, v92, v93
    v_cvt_pk_bf16_f32 v77, v94, v95
    v_cvt_pk_bf16_f32 v78, v96, v97
    v_cvt_pk_bf16_f32 v79, v98, v99
    s_waitcnt lgkmcnt(0)
    v_mfma_f32_32x32x16_bf16 v[84:99], v[48:51], v[24:27], v[116:131]
    v_exp_f32 v100, v100
    v_exp_f32 v101, v101
    v_exp_f32 v102, v102
    v_exp_f32 v103, v103
    v_mfma_f32_32x32x16_bf16 v[148:163], v[64:67], v[76:79], v[148:163]
    v_exp_f32 v104, v104
    v_exp_f32 v105, v105
    v_exp_f32 v106, v106
    v_exp_f32 v107, v107
    v_cvt_pk_bf16_f32 v72, v100, v101
    v_cvt_pk_bf16_f32 v73, v102, v103
    v_cvt_pk_bf16_f32 v74, v104, v105
    v_cvt_pk_bf16_f32 v75, v106, v107
    v_mfma_f32_32x32x8_bf16 v[84:99], v[54:55], v[32:33], v[84:99]
    v_exp_f32 v108, v108
    v_exp_f32 v109, v109
    v_exp_f32 v110, v110
    v_exp_f32 v111, v111
    v_mfma_f32_32x32x16_bf16 v[164:179], v[56:59], v[72:75], v[164:179]
    v_exp_f32 v112, v112
    v_exp_f32 v113, v113
    v_exp_f32 v114, v114
    v_exp_f32 v115, v115
    v_cvt_pk_bf16_f32 v76, v108, v109
    v_cvt_pk_bf16_f32 v77, v110, v111
    v_cvt_pk_bf16_f32 v78, v112, v113
    v_cvt_pk_bf16_f32 v79, v114, v115
    v_mfma_f32_32x32x16_bf16 v[100:115], v[48:51], v[28:31], v[132:147]
    ds_read2st64_b64 v[44:47], v5 offset0:40 offset1:41
    ds_read_b64 v[52:53], v7 offset:21504
    v_exp_f32 v84, v84
    v_exp_f32 v85, v85
    v_exp_f32 v86, v86
    v_exp_f32 v87, v87
    v_mfma_f32_32x32x16_bf16 v[164:179], v[64:67], v[76:79], v[164:179]
    s_mov_b64 exec, s[22:23]
    ds_read_b128 v[68:71], v17 offset:9600
    ds_read_b128 v[56:59], v17 offset:20480
    s_mov_b64 exec, -1
    v_exp_f32 v88, v88
    v_exp_f32 v89, v89
    v_exp_f32 v90, v90
    v_exp_f32 v91, v91
    v_cvt_pk_bf16_f32 v72, v84, v85
    v_cvt_pk_bf16_f32 v73, v86, v87
    v_cvt_pk_bf16_f32 v74, v88, v89
    v_cvt_pk_bf16_f32 v75, v90, v91
    v_mfma_f32_32x32x8_bf16 v[100:115], v[54:55], v[34:35], v[100:115]
    v_exp_f32 v92, v92
    v_exp_f32 v93, v93
    v_exp_f32 v94, v94
    v_exp_f32 v95, v95
    v_mfma_f32_32x32x16_bf16 v[148:163], v[60:63], v[72:75], v[148:163]
    v_exp_f32 v96, v96
    v_exp_f32 v97, v97
    v_exp_f32 v98, v98
    v_exp_f32 v99, v99
    v_cvt_pk_bf16_f32 v76, v92, v93
    v_cvt_pk_bf16_f32 v77, v94, v95
    v_cvt_pk_bf16_f32 v78, v96, v97
    v_cvt_pk_bf16_f32 v79, v98, v99
    s_waitcnt lgkmcnt(0)
    v_mfma_f32_32x32x16_bf16 v[84:99], v[44:47], v[24:27], v[116:131]
    v_exp_f32 v100, v100
    v_exp_f32 v101, v101
    v_exp_f32 v102, v102
    v_exp_f32 v103, v103
    v_mfma_f32_32x32x16_bf16 v[148:163], v[68:71], v[76:79], v[148:163]
    v_exp_f32 v104, v104
    v_exp_f32 v105, v105
    v_exp_f32 v106, v106
    v_exp_f32 v107, v107
    v_cvt_pk_bf16_f32 v72, v100, v101
    v_cvt_pk_bf16_f32 v73, v102, v103
    v_cvt_pk_bf16_f32 v74, v104, v105
    v_cvt_pk_bf16_f32 v75, v106, v107
    v_mfma_f32_32x32x8_bf16 v[84:99], v[52:53], v[32:33], v[84:99]
    v_exp_f32 v108, v108
    v_exp_f32 v109, v109
    v_exp_f32 v110, v110
    v_exp_f32 v111, v111
    v_mfma_f32_32x32x16_bf16 v[164:179], v[60:63], v[72:75], v[164:179]
    v_exp_f32 v112, v112
    v_exp_f32 v113, v113
    v_exp_f32 v114, v114
    v_exp_f32 v115, v115
    v_cvt_pk_bf16_f32 v76, v108, v109
    v_cvt_pk_bf16_f32 v77, v110, v111
    v_cvt_pk_bf16_f32 v78, v112, v113
    v_cvt_pk_bf16_f32 v79, v114, v115
    v_add_u32 v5, 20480, v5
    v_add_u32 v6, 20480, v6
    v_add_u32 v7, 20480, v7
    v_add_u32 v17, 20480, v17
K2_LOOPEND:
    v_mfma_f32_32x32x16_bf16 v[164:179], v[68:71], v[76:79], v[164:179]
    s_setprio 0
    s_mov_b32 s67, 0
    s_cmp_lg_u32 s21, 0
    s_cbranch_scc1 K2_XCHG
    s_waitcnt vmcnt(0) lgkmcnt(0)
    s_mov_b64 exec, s[24:25]
    s_not_b64 exec, exec
    v_mov_b32 v40, 0
    v_mov_b32 v41, 0
    s_mov_b64 exec, -1
    s_cmp_lg_u32 s15, 0
    s_cbranch_scc1 K2_NOFIX
    v_mov_b32 v204, 0xf149f2ca
    v_mov_b32 v205, 0xf149f2ca
    v_mov_b32 v206, 0xf149f2ca
    v_mov_b32 v207, 0xf149f2ca
    v_mov_b32 v208, 0xf149f2ca
    v_mov_b32 v209, 0xf149f2ca
    v_mov_b32 v210, 0xf149f2ca
    v_mov_b32 v211, 0xf149f2ca
    s_nop 1
K2_NOFIX:
    v_mfma_f32_32x32x16_bf16 v[84:99], v[180:183], v[36:39], v[204:219]
    v_mfma_f32_32x32x16_bf16 v[100:115], v[184:187], v[36:39], v[220:235]
    v_mfma_f32_32x32x8_bf16 v[84:99], v[188:189], v[40:41], v[84:99]
    v_mfma_f32_32x32x8_bf16 v[100:115], v[190:191], v[40:41], v[100:115]
    v_mov_b64 v[10:11], 0
    v_mov_b64 v[12:13], 0
    v_mov_b32 v9, 0x5f800000
    s_nop 3
    v_pk_fma_f32 v[10:11], v[148:149], v[12:13], v[10:11]
    v_pk_fma_f32 v[10:11], v[164:165], v[12:13], v[10:11]
    v_pk_fma_f32 v[10:11], v[150:151], v[12:13], v[10:11]
    v_pk_fma_f32 v[10:11], v[166:167], v[12:13], v[10:11]
    v_pk_fma_f32 v[10:11], v[152:153], v[12:13], v[10:11]
    v_pk_fma_f32 v[10:11], v[168:169], v[12:13], v[10:11]
    v_pk_fma_f32 v[10:11], v[154:155], v[12:13], v[10:11]
    v_pk_fma_f32 v[10:11], v[170:171], v[12:13], v[10:11]
    v_pk_fma_f32 v[10:11], v[156:157], v[12:13], v[10:11]
    v_pk_fma_f32 v[10:11], v[172:173], v[12:13], v[10:11]
    v_pk_fma_f32 v[10:11], v[158:159], v[12:13], v[10:11]
    v_pk_fma_f32 v[10:11], v[174:175], v[12:13], v[10:11]
    v_add_f32 v8, v160, v176
    v_add_f32 v10, v10, v11
    v_add_f32 v8, v8, v10
    v_cmp_nlt_f32 vcc, v8, v9
    v_mov_b32 v161, v116
    v_mov_b32 v177, v132
    s_nop 1
    s_cmp_lg_u64 vcc, 0
    s_cselect_b32 s67, 1, 0
    v_max3_f32 v14, v84, v85, v86
    v_max3_f32 v14, v14, v87, v88
    v_max3_f32 v14, v14, v89, v90
    v_max3_f32 v14, v14, v91, v92
    v_max3_f32 v14, v14, v93, v94
    v_max3_f32 v14, v14, v95, v96
    v_max3_f32 v14, v14, v97, v98
    v_max3_f32 v14, v14, v99, v100
    v_max3_f32 v14, v14, v101, v102
    v_max3_f32 v14, v14, v103, v104
    v_max3_f32 v14, v14, v105, v106
    v_max_f32 v14, v14, v107
    v_mov_b32 v15, v14
    s_nop 1
    v_permlane32_swap_b32 v14, v15
    s_nop 1
    v_max_f32 v14, v14, v15
    v_sub_f32 v6, 0, v14
    v_sub_f32 v7, 0, v14
    v_pk_add_f32 v[84:85], v[84:85], v[6:7]
    v_pk_add_f32 v[86:87], v[86:87], v[6:7]
    v_pk_add_f32 v[88:89], v[88:89], v[6:7]
    v_pk_add_f32 v[90:91], v[90:91], v[6:7]
    v_pk_add_f32 v[92:93], v[92:93], v[6:7]
    v_pk_add_f32 v[94:95], v[94:95], v[6:7]
    v_pk_add_f32 v[96:97], v[96:97], v[6:7]
    v_pk_add_f32 v[98:99], v[98:99], v[6:7]
    v_pk_add_f32 v[100:101], v[100:101], v[6:7]
    v_pk_add_f32 v[102:103], v[102:103], v[6:7]
    v_pk_add_f32 v[104:105], v[104:105], v[6:7]
    v_pk_add_f32 v[106:107], v[106:107], v[6:7]
    v_exp_f32 v84, v84
    v_exp_f32 v85, v85
    v_exp_f32 v86, v86
    v_exp_f32 v87, v87
    v_exp_f32 v88, v88
    v_exp_f32 v89, v89
    v_exp_f32 v90, v90
    v_exp_f32 v91, v91
    v_exp_f32 v92, v92
    v_exp_f32 v93, v93
    v_exp_f32 v94, v94
    v_exp_f32 v95, v95
    v_exp_f32 v96, v96
    v_exp_f32 v97, v97
    v_exp_f32 v98, v98
    v_exp_f32 v99, v99
    v_exp_f32 v100, v100
    v_exp_f32 v101, v101
    v_exp_f32 v102, v102
    v_exp_f32 v103, v103
    v_exp_f32 v104, v104
    v_exp_f32 v105, v105
    v_exp_f32 v106, v106
    v_exp_f32 v107, v107
    s_nop 0
    v_cvt_pk_bf16_f32 v72, v84, v85
    v_cvt_pk_bf16_f32 v73, v86, v87
    v_cvt_pk_bf16_f32 v74, v88, v89
    v_cvt_pk_bf16_f32 v75, v90, v91
    v_cvt_pk_bf16_f32 v76, v92, v93
    v_cvt_pk_bf16_f32 v77, v94, v95
    v_cvt_pk_bf16_f32 v78, v96, v97
    v_cvt_pk_bf16_f32 v79, v98, v99
    v_cvt_pk_bf16_f32 v80, v100, v101
    v_cvt_pk_bf16_f32 v81, v102, v103
    v_cvt_pk_bf16_f32 v82, v104, v105
    v_cvt_pk_bf16_f32 v83, v106, v107
    s_nop 1
    v_mfma_f32_32x32x16_bf16 v[116:131], v[192:195], v[72:75], 0
    v_mfma_f32_32x32x16_bf16 v[116:131], v[196:199], v[76:79], v[116:131]
    v_mfma_f32_32x32x16_bf16 v[116:131], v[200:203], v[80:83], v[116:131]
    s_nop 15
    v_mov_b32 v14, v128
    s_not_b64 exec, s[24:25]
    v_mov_b32 v14, v124
    s_mov_b64 exec, -1
    v_rcp_f32 v14, v14
    s_nop 0
    v_mul_f32 v14, v14, v16
    v_pk_mul_f32 v[116:117], v[116:117], v[14:15] op_sel_hi:[1,0]
    v_pk_mul_f32 v[118:119], v[118:119], v[14:15] op_sel_hi:[1,0]
    v_pk_mul_f32 v[120:121], v[120:121], v[14:15] op_sel_hi:[1,0]
    v_pk_mul_f32 v[122:123], v[122:123], v[14:15] op_sel_hi:[1,0]
    v_pk_mul_f32 v[124:125], v[124:125], v[14:15] op_sel_hi:[1,0]
    v_pk_mul_f32 v[126:127], v[126:127], v[14:15] op_sel_hi:[1,0]
    v_cvt_pk_bf16_f32 v72, v116, v117
    v_cvt_pk_bf16_f32 v73, v118, v119
    v_cvt_pk_bf16_f32 v74, v120, v121
    v_cvt_pk_bf16_f32 v75, v122, v123
    v_cvt_pk_bf16_f32 v240, v124, v125
    v_cvt_pk_bf16_f32 v241, v126, v127
    s_nop 1
    v_permlane32_swap_b32 v72, v74
    v_permlane32_swap_b32 v73, v75
    s_mov_b32 s17, 17825792
    buffer_store_dwordx4 v[72:75], v245, s[8:11], s17 offen offset:0 sc1
    s_branch K2_XCHG1
K2_XCHG:
    s_nop 15
    v_mov_b32 v161, v116
    v_mov_b32 v177, v132
K2_XCHG1:
    s_mul_i32 s16, s26, 81920
    s_lshl_b32 s18, s27, 12
    s_add_u32 s18, s18, 61440
    s_add_u32 s16, s16, s18
    v_add_u32 v8, s16, v2
    s_xor_b32 s16, s26, 1
    s_mul_i32 s16, s16, 81920
    s_add_u32 s16, s16, s18
    v_add_u32 v9, s16, v2
    s_lshl_b32 s16, s12, 2
    s_add_u32 s16, s16, 77824
    v_mov_b32 v10, s16
    v_mov_b32 v11, s67
    s_barrier
    s_cmp_eq_u32 s26, 0
    s_cbranch_scc1 K2_XA
    ds_write_b128 v8, v[148:151] offset:0
    ds_write_b128 v8, v[152:155] offset:1024
    ds_write_b128 v8, v[156:159] offset:2048
    ds_write_b128 v8, v[160:163] offset:3072
    s_branch K2_XB
K2_XA:
    ds_write_b128 v8, v[164:167] offset:0
    ds_write_b128 v8, v[168:171] offset:1024
    ds_write_b128 v8, v[172:175] offset:2048
    ds_write_b128 v8, v[176:179] offset:3072
K2_XB:
    ds_write_b32 v10, v11
    v_mov_b32 v10, 77824
    s_waitcnt lgkmcnt(0)
    s_barrier
    ds_read_b128 v[12:15], v10
    ds_read_b128 v[84:87], v10 offset:16
    s_cmp_eq_u32 s26, 0
    s_cbranch_scc1 K2_XC
    ds_read_b128 v[148:151], v9 offset:0
    ds_read_b128 v[152:155], v9 offset:1024
    ds_read_b128 v[156:159], v9 offset:2048
    ds_read_b128 v[160:163], v9 offset:3072
    s_branch K2_XD
K2_XC:
    ds_read_b128 v[164:167], v9 offset:0
    ds_read_b128 v[168:171], v9 offset:1024
    ds_read_b128 v[172:175], v9 offset:2048
    ds_read_b128 v[176:179], v9 offset:3072
K2_XD:
    s_waitcnt lgkmcnt(4)
    v_or3_b32 v12, v12, v13, v14
    v_or3_b32 v12, v12, v15, v84
    v_or3_b32 v12, v12, v85, v86
    v_or_b32 v12, v12, v87
    s_nop 0
    v_readfirstlane_b32 s16, v12
    s_nop 3
    s_cmp_lg_u32 s16, 0
    s_cbranch_scc1 K2_REDO
    s_waitcnt lgkmcnt(0)
    v_sub_f32 v10, v177, v161
    v_sub_f32 v11, 0, v10
    v_min_f32 v10, 0, v10
    v_min_f32 v11, 0, v11
    v_exp_f32 v10, v10
    v_exp_f32 v11, v11
    v_mov_b32 v12, v160
    s_not_b64 exec, s[24:25]
    v_mov_b32 v12, v156
    s_mov_b64 exec, -1
    v_mov_b32 v13, v176
    s_not_b64 exec, s[24:25]
    v_mov_b32 v13, v172
    s_mov_b64 exec, -1
    v_mul_f32 v12, v12, v10
    v_fmac_f32 v12, v13, v11
    v_rcp_f32 v12, v12
    v_sub_f32 v13, 1.0, v16
    s_nop 0
    v_mul_f32 v12, v12, v13
    v_mul_f32 v10, v10, v12
    v_mul_f32 v11, v11, v12
    v_pk_mul_f32 v[148:149], v[148:149], v[10:11] op_sel_hi:[1,0]
    v_pk_fma_f32 v[148:149], v[164:165], v[10:11], v[148:149] op_sel:[0,1,0] op_sel_hi:[1,1,1]
    v_pk_mul_f32 v[150:151], v[150:151], v[10:11] op_sel_hi:[1,0]
    v_pk_fma_f32 v[150:151], v[166:167], v[10:11], v[150:151] op_sel:[0,1,0] op_sel_hi:[1,1,1]
    v_pk_mul_f32 v[152:153], v[152:153], v[10:11] op_sel_hi:[1,0]
    v_pk_fma_f32 v[152:153], v[168:169], v[10:11], v[152:153] op_sel:[0,1,0] op_sel_hi:[1,1,1]
    v_pk_mul_f32 v[154:155], v[154:155], v[10:11] op_sel_hi:[1,0]
    v_pk_fma_f32 v[154:155], v[170:171], v[10:11], v[154:155] op_sel:[0,1,0] op_sel_hi:[1,1,1]
    v_pk_mul_f32 v[156:157], v[156:157], v[10:11] op_sel_hi:[1,0]
    v_pk_fma_f32 v[156:157], v[172:173], v[10:11], v[156:157] op_sel:[0,1,0] op_sel_hi:[1,1,1]
    v_pk_mul_f32 v[158:159], v[158:159], v[10:11] op_sel_hi:[1,0]
    v_pk_fma_f32 v[158:159], v[174:175], v[10:11], v[158:159] op_sel:[0,1,0] op_sel_hi:[1,1,1]
    v_cvt_pk_bf16_f32 v236, v148, v149
    v_cvt_pk_bf16_f32 v237, v150, v151
    v_cvt_pk_bf16_f32 v238, v152, v153
    v_cvt_pk_bf16_f32 v239, v154, v155
    v_cvt_pk_bf16_f32 v242, v156, v157
    v_cvt_pk_bf16_f32 v243, v158, v159
    s_nop 1
    v_permlane32_swap_b32 v236, v238
    v_permlane32_swap_b32 v237, v239
    s_mov_b32 s17, 17825792
    buffer_store_dwordx4 v[236:239], v245, s[8:11], s17 offen offset:512 sc1
    s_mov_b64 exec, s[24:25]
    buffer_store_dwordx4 v[240:243], v245, s[8:11], s17 offen offset:1024 sc1
    s_mov_b64 exec, -1
    s_cmp_eq_u32 s21, 0
    s_cbranch_scc1 K2_WOK
    s_barrier
    s_mov_b32 s49, 0
    s_mov_b32 s58, s59
    s_add_u32 m0, s44, s49
    s_add_u32 s19, s58, 0
    buffer_load_dwordx4 v2, s[8:11], s19 offen lds
    s_add_u32 m0, s45, s49
    s_add_u32 s19, s58, 8192
    buffer_load_dwordx4 v2, s[8:11], s19 offen lds
    s_add_u32 m0, s46, s49
    s_add_u32 s19, s58, 16384
    buffer_load_dwordx4 v2, s[8:11], s19 offen lds
    s_add_u32 m0, s47, s49
    s_add_u32 s19, s58, 24576
    buffer_load_dwordx4 v2, s[8:11], s19 offen lds
    s_add_u32 m0, s48, s49
    s_add_u32 s19, s58, 32768
    buffer_load_dwordx4 v2, s[8:11], s19 offen lds
    s_add_u32 s49, s49, 20480
    s_add_u32 s58, s58, 40960
    s_add_u32 m0, s44, s49
    s_add_u32 s19, s58, 0
    buffer_load_dwordx4 v2, s[8:11], s19 offen lds
    s_add_u32 m0, s45, s49
    s_add_u32 s19, s58, 8192
    buffer_load_dwordx4 v2, s[8:11], s19 offen lds
    s_add_u32 m0, s46, s49
    s_add_u32 s19, s58, 16384
    buffer_load_dwordx4 v2, s[8:11], s19 offen lds
    s_add_u32 m0, s47, s49
    s_add_u32 s19, s58, 24576
    buffer_load_dwordx4 v2, s[8:11], s19 offen lds
    s_add_u32 m0, s48, s49
    s_add_u32 s19, s58, 32768
    buffer_load_dwordx4 v2, s[8:11], s19 offen lds
    s_add_u32 s49, s49, 20480
    s_add_u32 s58, s58, 40960
    s_waitcnt vmcnt(0)
K2_WOK:
    s_mov_b32 s49, 40960
    s_add_u32 m0, s44, s49
    s_add_u32 s19, s58, 0
    buffer_load_dwordx4 v2, s[8:11], s19 offen lds
    s_add_u32 m0, s45, s49
    s_add_u32 s19, s58, 8192
    buffer_load_dwordx4 v2, s[8:11], s19 offen lds
    s_add_u32 m0, s46, s49
    s_add_u32 s19, s58, 16384
    buffer_load_dwordx4 v2, s[8:11], s19 offen lds
    s_add_u32 m0, s47, s49
    s_add_u32 s19, s58, 24576
    buffer_load_dwordx4 v2, s[8:11], s19 offen lds
    s_add_u32 m0, s48, s49
    s_add_u32 s19, s58, 32768
    buffer_load_dwordx4 v2, s[8:11], s19 offen lds
    s_add_u32 s58, s58, 40960
    s_waitcnt vmcnt(5)
    s_barrier
    s_cmp_lg_u32 s12, 0
    s_cbranch_scc1 K2_NOPOLL0
    s_lshl_b32 s16, s14, 12
    s_add_u32 s16, s16, 15745024
    s_mov_b64 exec, s[24:25]
    v_mov_b32 v8, 1
    v_lshlrev_b32 v13, 7, v1
    buffer_atomic_add v8, v13, s[8:11], s16 offen
    s_mov_b64 exec, -1
K2_NOPOLL0:
    s_mov_b32 s49, 61440
    s_add_u32 m0, s44, s49
    s_add_u32 s19, s58, 0
    buffer_load_dwordx4 v2, s[8:11], s19 offen lds
    s_add_u32 m0, s45, s49
    s_add_u32 s19, s58, 8192
    buffer_load_dwordx4 v2, s[8:11], s19 offen lds
    s_add_u32 m0, s46, s49
    s_add_u32 s19, s58, 16384
    buffer_load_dwordx4 v2, s[8:11], s19 offen lds
    s_add_u32 m0, s47, s49
    s_add_u32 s19, s58, 24576
    buffer_load_dwordx4 v2, s[8:11], s19 offen lds
    s_add_u32 m0, s48, s49
    s_add_u32 s19, s58, 32768
    buffer_load_dwordx4 v2, s[8:11], s19 offen lds
    s_add_u32 s49, s49, 20480
    s_add_u32 s58, s58, 40960
    s_and_b32 s50, s12, 3
    s_lshr_b32 s51, s12, 2
    s_lshl_b32 s57, s12, 10
    s_mul_i32 s56, s65, 204800
    s_add_u32 s56, s56, s57
    s_add_u32 s56, s56, 15794176
    s_lshl_b32 s55, s64, 2
    s_add_u32 s55, s55, s50
    s_mul_i32 s58, s55, 20480
    s_mul_i32 s55, s55, 40
    s_lshl_b32 s52, s51, 1
    s_add_u32 s55, s55, s52
    s_lshl_b32 s55, s55, 10
    s_add_u32 s55, s55, 17825792
    s_mul_i32 s54, s65, 160
    s_add_u32 s58, s58, s54
    s_mov_b32 s68, s60
    s_and_b32 s69, s61, 0xffff
    s_mov_b32 s70, 2621440
    s_mov_b32 s71, 0x00020000
    s_mul_i32 s52, s51, 10240
    v_add_u32 v6, s52, v2
    v_and_b32 v9, 15, v1
    v_mul_u32_u24 v9, 1280, v9
    v_lshrrev_b32 v10, 4, v1
    v_lshl_add_u32 v9, v10, 3, v9
    s_mul_i32 s52, s12, 3072
    s_add_u32 s52, s52, 0
    v_add_u32 v8, s52, v2
    s_xor_b32 s54, s12, 4
    s_mul_i32 s54, s54, 3072
    s_add_u32 s54, s54, 0
    v_add_u32 v11, s54, v2
    s_cmp_lg_u32 s12, 0
    s_cbranch_scc1 K2_NOPOLL
    s_lshl_b32 s16, s13, 3
    s_add_u32 s16, s16, s14
    s_lshl_b32 s16, s16, 7
    s_add_u32 s16, s16, 15745024
    s_mov_b64 exec, 1
    v_mov_b32 v13, 0
    s_mov_b32 s17, 0
K2_POLL:
    buffer_load_dword v12, v13, s[8:11], s16 offen sc1
    s_waitcnt vmcnt(0)
    v_readfirstlane_b32 s18, v12
    s_add_u32 s17, s17, 1
    s_cmp_ge_u32 s18, 32
    s_cbranch_scc1 K2_POLLED
    s_sleep 2
    s_cmp_lt_u32 s17, 0x40000
    s_cbranch_scc1 K2_POLL
K2_POLLED:
    s_waitcnt vmcnt(0)
    s_mov_b64 exec, -1
K2_NOPOLL:
    s_waitcnt vmcnt(0)
    s_barrier
    s_add_u32 s52, s55, 0
    buffer_load_dwordx4 v[20:23], v2, s[8:11], s52 offen sc1
    s_add_u32 s52, s55, 1024
    buffer_load_dwordx4 v[24:27], v2, s[8:11], s52 offen sc1
    s_add_u32 s52, s55, 4096
    buffer_load_dwordx4 v[28:31], v2, s[8:11], s52 offen sc1
    s_add_u32 s52, s55, 5120
    buffer_load_dwordx4 v[32:35], v2, s[8:11], s52 offen sc1
    s_add_u32 s52, s55, 8192
    buffer_load_dwordx4 v[36:39], v2, s[8:11], s52 offen sc1
    s_add_u32 s52, s55, 9216
    buffer_load_dwordx4 v[40:43], v2, s[8:11], s52 offen sc1
    s_add_u32 s52, s55, 12288
    buffer_load_dwordx4 v[44:47], v2, s[8:11], s52 offen sc1
    s_add_u32 s52, s55, 13312
    buffer_load_dwordx4 v[48:51], v2, s[8:11], s52 offen sc1
    s_waitcnt vmcnt(8)
    s_barrier
    v_add_u32 v7, 0, v6
    ds_read_b128 v[100:103], v7 offset:0
    ds_read_b128 v[104:107], v7 offset:1024
    ds_read_b128 v[108:111], v7 offset:2048
    ds_read_b128 v[112:115], v7 offset:3072
    ds_read_b128 v[116:119], v7 offset:4096
    ds_read_b128 v[120:123], v7 offset:5120
    ds_read_b128 v[124:127], v7 offset:6144
    ds_read_b128 v[128:131], v7 offset:7168
    ds_read_b128 v[132:135], v7 offset:8192
    ds_read_b128 v[136:139], v7 offset:9216
    s_waitcnt vmcnt(6) lgkmcnt(0)
    v_mfma_f32_16x16x32_bf16 v[180:183], v[100:103], v[20:23], 0
    v_add_u32 v7, 81920, v6
    ds_read_b128 v[140:143], v7 offset:0
    v_mfma_f32_16x16x32_bf16 v[184:187], v[104:107], v[20:23], 0
    ds_read_b128 v[144:147], v7 offset:1024
    v_mfma_f32_16x16x32_bf16 v[188:191], v[108:111], v[20:23], 0
    ds_read_b128 v[148:151], v7 offset:2048
    ds_read_b128 v[152:155], v7 offset:3072
    v_mfma_f32_16x16x32_bf16 v[192:195], v[112:115], v[20:23], 0
    s_add_u32 s52, s55, 16384
    buffer_load_dwordx4 v[52:55], v2, s[8:11], s52 offen sc1
    v_mfma_f32_16x16x32_bf16 v[196:199], v[116:119], v[20:23], 0
    ds_read_b128 v[156:159], v7 offset:4096
    ds_read_b128 v[160:163], v7 offset:5120
    v_mfma_f32_16x16x32_bf16 v[180:183], v[120:123], v[24:27], v[180:183]
    ds_read_b128 v[164:167], v7 offset:6144
    v_mfma_f32_16x16x32_bf16 v[184:187], v[124:127], v[24:27], v[184:187]
    ds_read_b128 v[168:171], v7 offset:7168
    ds_read_b128 v[172:175], v7 offset:8192
    v_mfma_f32_16x16x32_bf16 v[188:191], v[128:131], v[24:27], v[188:191]
    s_add_u32 s52, s55, 17408
    buffer_load_dwordx4 v[56:59], v2, s[8:11], s52 offen sc1
    v_mfma_f32_16x16x32_bf16 v[192:195], v[132:135], v[24:27], v[192:195]
    ds_read_b128 v[176:179], v7 offset:9216
    v_mfma_f32_16x16x32_bf16 v[196:199], v[136:139], v[24:27], v[196:199]
    s_waitcnt vmcnt(6) lgkmcnt(0)
    s_barrier
    v_mfma_f32_16x16x32_bf16 v[180:183], v[140:143], v[28:31], v[180:183]
    v_add_u32 v7, 20480, v6
    s_add_u32 m0, s44, 0
    s_add_u32 s53, s56, 163840
    buffer_load_dwordx4 v2, s[8:11], s53 offen lds
    v_mfma_f32_16x16x32_bf16 v[184:187], v[144:147], v[28:31], v[184:187]
    ds_read_b128 v[100:103], v7 offset:0
    s_add_u32 m0, s45, 0
    s_add_u32 s53, s56, 172032
    buffer_load_dwordx4 v2, s[8:11], s53 offen lds
    v_mfma_f32_16x16x32_bf16 v[188:191], v[148:151], v[28:31], v[188:191]
    ds_read_b128 v[104:107], v7 offset:1024
    s_add_u32 m0, s46, 0
    s_add_u32 s53, s56, 180224
    buffer_load_dwordx4 v2, s[8:11], s53 offen lds
    v_mfma_f32_16x16x32_bf16 v[192:195], v[152:155], v[28:31], v[192:195]
    ds_read_b128 v[108:111], v7 offset:2048
    s_add_u32 m0, s47, 0
    s_add_u32 s53, s56, 188416
    buffer_load_dwordx4 v2, s[8:11], s53 offen lds
    v_mfma_f32_16x16x32_bf16 v[196:199], v[156:159], v[28:31], v[196:199]
    ds_read_b128 v[112:115], v7 offset:3072
    s_add_u32 m0, s48, 0
    s_add_u32 s53, s56, 196608
    buffer_load_dwordx4 v2, s[8:11], s53 offen lds
    v_mfma_f32_16x16x32_bf16 v[180:183], v[160:163], v[32:35], v[180:183]
    ds_read_b128 v[116:119], v7 offset:4096
    s_add_u32 s52, s55, 20480
    buffer_load_dwordx4 v[60:63], v2, s[8:11], s52 offen sc1
    v_mfma_f32_16x16x32_bf16 v[184:187], v[164:167], v[32:35], v[184:187]
    ds_read_b128 v[120:123], v7 offset:5120
    s_add_u32 s52, s55, 21504
    buffer_load_dwordx4 v[64:67], v2, s[8:11], s52 offen sc1
    v_mfma_f32_16x16x32_bf16 v[188:191], v[168:171], v[32:35], v[188:191]
    ds_read_b128 v[124:127], v7 offset:6144
    ds_read_b128 v[128:131], v7 offset:7168
    v_mfma_f32_16x16x32_bf16 v[192:195], v[172:175], v[32:35], v[192:195]
    ds_read_b128 v[132:135], v7 offset:8192
    ds_read_b128 v[136:139], v7 offset:9216
    v_mfma_f32_16x16x32_bf16 v[196:199], v[176:179], v[32:35], v[196:199]
    s_waitcnt vmcnt(11) lgkmcnt(0)
    v_mfma_f32_16x16x32_bf16 v[180:183], v[100:103], v[36:39], v[180:183]
    v_add_u32 v7, 102400, v6
    ds_read_b128 v[140:143], v7 offset:0
    v_mfma_f32_16x16x32_bf16 v[184:187], v[104:107], v[36:39], v[184:187]
    ds_read_b128 v[144:147], v7 offset:1024
    v_mfma_f32_16x16x32_bf16 v[188:191], v[108:111], v[36:39], v[188:191]
    ds_read_b128 v[148:151], v7 offset:2048
    ds_read_b128 v[152:155], v7 offset:3072
    v_mfma_f32_16x16x32_bf16 v[192:195], v[112:115], v[36:39], v[192:195]
    s_add_u32 s52, s55, 24576
    buffer_load_dwordx4 v[68:71], v2, s[8:11], s52 offen sc1
    v_mfma_f32_16x16x32_bf16 v[196:199], v[116:119], v[36:39], v[196:199]
    ds_read_b128 v[156:159], v7 offset:4096
    ds_read_b128 v[160:163], v7 offset:5120
    v_mfma_f32_16x16x32_bf16 v[180:183], v[120:123], v[40:43], v[180:183]
    ds_read_b128 v[164:167], v7 offset:6144
    v_mfma_f32_16x16x32_bf16 v[184:187], v[124:127], v[40:43], v[184:187]
    ds_read_b128 v[168:171], v7 offset:7168
    ds_read_b128 v[172:175], v7 offset:8192
    v_mfma_f32_16x16x32_bf16 v[188:191], v[128:131], v[40:43], v[188:191]
    s_add_u32 s52, s55, 25600
    buffer_load_dwordx4 v[72:75], v2, s[8:11], s52 offen sc1
    v_mfma_f32_16x16x32_bf16 v[192:195], v[132:135], v[40:43], v[192:195]
    ds_read_b128 v[176:179], v7 offset:9216
    v_mfma_f32_16x16x32_bf16 v[196:199], v[136:139], v[40:43], v[196:199]
    s_waitcnt vmcnt(11) lgkmcnt(0)
    s_barrier
    v_mfma_f32_16x16x32_bf16 v[180:183], v[140:143], v[44:47], v[180:183]
    v_add_u32 v7, 40960, v6
    ds_read_b128 v[100:103], v7 offset:0
    v_mfma_f32_16x16x32_bf16 v[184:187], v[144:147], v[44:47], v[184:187]
    ds_read_b128 v[104:107], v7 offset:1024
    v_mfma_f32_16x16x32_bf16 v[188:191], v[148:151], v[44:47], v[188:191]
    ds_read_b128 v[108:111], v7 offset:2048
    ds_read_b128 v[112:115], v7 offset:3072
    v_mfma_f32_16x16x32_bf16 v[192:195], v[152:155], v[44:47], v[192:195]
    s_add_u32 s52, s55, 28672
    buffer_load_dwordx4 v[76:79], v2, s[8:11], s52 offen sc1
    v_mfma_f32_16x16x32_bf16 v[196:199], v[156:159], v[44:47], v[196:199]
    ds_read_b128 v[116:119], v7 offset:4096
    ds_read_b128 v[120:123], v7 offset:5120
    v_mfma_f32_16x16x32_bf16 v[180:183], v[160:163], v[48:51], v[180:183]
    ds_read_b128 v[124:127], v7 offset:6144
    v_mfma_f32_16x16x32_bf16 v[184:187], v[164:167], v[48:51], v[184:187]
    ds_read_b128 v[128:131], v7 offset:7168
    ds_read_b128 v[132:135], v7 offset:8192
    v_mfma_f32_16x16x32_bf16 v[188:191], v[168:171], v[48:51], v[188:191]
    s_add_u32 s52, s55, 29696
    buffer_load_dwordx4 v[80:83], v2, s[8:11], s52 offen sc1
    v_mfma_f32_16x16x32_bf16 v[192:195], v[172:175], v[48:51], v[192:195]
    ds_read_b128 v[136:139], v7 offset:9216
    v_mfma_f32_16x16x32_bf16 v[196:199], v[176:179], v[48:51], v[196:199]
    s_waitcnt vmcnt(11) lgkmcnt(0)
    v_mfma_f32_16x16x32_bf16 v[180:183], v[100:103], v[52:55], v[180:183]
    v_add_u32 v7, 122880, v6
    ds_read_b128 v[140:143], v7 offset:0
    v_mfma_f32_16x16x32_bf16 v[184:187], v[104:107], v[52:55], v[184:187]
    ds_read_b128 v[144:147], v7 offset:1024
    v_mfma_f32_16x16x32_bf16 v[188:191], v[108:111], v[52:55], v[188:191]
    ds_read_b128 v[148:151], v7 offset:2048
    ds_read_b128 v[152:155], v7 offset:3072
    v_mfma_f32_16x16x32_bf16 v[192:195], v[112:115], v[52:55], v[192:195]
    s_add_u32 s52, s55, 32768
    buffer_load_dwordx4 v[84:87], v2, s[8:11], s52 offen sc1
    v_mfma_f32_16x16x32_bf16 v[196:199], v[116:119], v[52:55], v[196:199]
    ds_read_b128 v[156:159], v7 offset:4096
    ds_read_b128 v[160:163], v7 offset:5120
    v_mfma_f32_16x16x32_bf16 v[180:183], v[120:123], v[56:59], v[180:183]
    ds_read_b128 v[164:167], v7 offset:6144
    v_mfma_f32_16x16x32_bf16 v[184:187], v[124:127], v[56:59], v[184:187]
    ds_read_b128 v[168:171], v7 offset:7168
    ds_read_b128 v[172:175], v7 offset:8192
    v_mfma_f32_16x16x32_bf16 v[188:191], v[128:131], v[56:59], v[188:191]
    s_add_u32 s52, s55, 33792
    buffer_load_dwordx4 v[88:91], v2, s[8:11], s52 offen sc1
    v_mfma_f32_16x16x32_bf16 v[192:195], v[132:135], v[56:59], v[192:195]
    ds_read_b128 v[176:179], v7 offset:9216
    v_mfma_f32_16x16x32_bf16 v[196:199], v[136:139], v[56:59], v[196:199]
    s_waitcnt vmcnt(6) lgkmcnt(0)
    s_barrier
    v_mfma_f32_16x16x32_bf16 v[180:183], v[140:143], v[60:63], v[180:183]
    v_add_u32 v7, 61440, v6
    ds_read_b128 v[100:103], v7 offset:0
    v_mfma_f32_16x16x32_bf16 v[184:187], v[144:147], v[60:63], v[184:187]
    ds_read_b128 v[104:107], v7 offset:1024
    v_mfma_f32_16x16x32_bf16 v[188:191], v[148:151], v[60:63], v[188:191]
    ds_read_b128 v[108:111], v7 offset:2048
    ds_read_b128 v[112:115], v7 offset:3072
    v_mfma_f32_16x16x32_bf16 v[192:195], v[152:155], v[60:63], v[192:195]
    s_add_u32 s52, s55, 36864
    buffer_load_dwordx4 v[92:95], v2, s[8:11], s52 offen sc1
    v_mfma_f32_16x16x32_bf16 v[196:199], v[156:159], v[60:63], v[196:199]
    ds_read_b128 v[116:119], v7 offset:4096
    ds_read_b128 v[120:123], v7 offset:5120
    v_mfma_f32_16x16x32_bf16 v[180:183], v[160:163], v[64:67], v[180:183]
    ds_read_b128 v[124:127], v7 offset:6144
    v_mfma_f32_16x16x32_bf16 v[184:187], v[164:167], v[64:67], v[184:187]
    ds_read_b128 v[128:131], v7 offset:7168
    ds_read_b128 v[132:135], v7 offset:8192
    v_mfma_f32_16x16x32_bf16 v[188:191], v[168:171], v[64:67], v[188:191]
    s_add_u32 s52, s55, 37888
    buffer_load_dwordx4 v[96:99], v2, s[8:11], s52 offen sc1
    v_mfma_f32_16x16x32_bf16 v[192:195], v[172:175], v[64:67], v[192:195]
    ds_read_b128 v[136:139], v7 offset:9216
    v_mfma_f32_16x16x32_bf16 v[196:199], v[176:179], v[64:67], v[196:199]
    s_waitcnt vmcnt(6) lgkmcnt(0)
    v_mfma_f32_16x16x32_bf16 v[180:183], v[100:103], v[68:71], v[180:183]
    v_add_u32 v7, 143360, v6
    ds_read_b128 v[140:143], v7 offset:0
    v_mfma_f32_16x16x32_bf16 v[184:187], v[104:107], v[68:71], v[184:187]
    ds_read_b128 v[144:147], v7 offset:1024
    v_mfma_f32_16x16x32_bf16 v[188:191], v[108:111], v[68:71], v[188:191]
    ds_read_b128 v[148:151], v7 offset:2048
    v_mfma_f32_16x16x32_bf16 v[192:195], v[112:115], v[68:71], v[192:195]
    ds_read_b128 v[152:155], v7 offset:3072
    v_mfma_f32_16x16x32_bf16 v[196:199], v[116:119], v[68:71], v[196:199]
    ds_read_b128 v[156:159], v7 offset:4096
    ds_read_b128 v[160:163], v7 offset:5120
    v_mfma_f32_16x16x32_bf16 v[180:183], v[120:123], v[72:75], v[180:183]
    ds_read_b128 v[164:167], v7 offset:6144
    v_mfma_f32_16x16x32_bf16 v[184:187], v[124:127], v[72:75], v[184:187]
    ds_read_b128 v[168:171], v7 offset:7168
    v_mfma_f32_16x16x32_bf16 v[188:191], v[128:131], v[72:75], v[188:191]
    ds_read_b128 v[172:175], v7 offset:8192
    v_mfma_f32_16x16x32_bf16 v[192:195], v[132:135], v[72:75], v[192:195]
    ds_read_b128 v[176:179], v7 offset:9216
    v_mfma_f32_16x16x32_bf16 v[196:199], v[136:139], v[72:75], v[196:199]
    s_waitcnt vmcnt(4) lgkmcnt(0)
    s_barrier
    v_mfma_f32_16x16x32_bf16 v[180:183], v[140:143], v[76:79], v[180:183]
    v_add_u32 v7, 0, v6
    ds_read_b128 v[100:103], v7 offset:0
    v_mfma_f32_16x16x32_bf16 v[184:187], v[144:147], v[76:79], v[184:187]
    ds_read_b128 v[104:107], v7 offset:1024
    v_mfma_f32_16x16x32_bf16 v[188:191], v[148:151], v[76:79], v[188:191]
    ds_read_b128 v[108:111], v7 offset:2048
    v_mfma_f32_16x16x32_bf16 v[192:195], v[152:155], v[76:79], v[192:195]
    ds_read_b128 v[112:115], v7 offset:3072
    v_mfma_f32_16x16x32_bf16 v[196:199], v[156:159], v[76:79], v[196:199]
    ds_read_b128 v[116:119], v7 offset:4096
    ds_read_b128 v[120:123], v7 offset:5120
    v_mfma_f32_16x16x32_bf16 v[180:183], v[160:163], v[80:83], v[180:183]
    ds_read_b128 v[124:127], v7 offset:6144
    v_mfma_f32_16x16x32_bf16 v[184:187], v[164:167], v[80:83], v[184:187]
    ds_read_b128 v[128:131], v7 offset:7168
    v_mfma_f32_16x16x32_bf16 v[188:191], v[168:171], v[80:83], v[188:191]
    ds_read_b128 v[132:135], v7 offset:8192
    v_mfma_f32_16x16x32_bf16 v[192:195], v[172:175], v[80:83], v[192:195]
    ds_read_b128 v[136:139], v7 offset:9216
    v_mfma_f32_16x16x32_bf16 v[196:199], v[176:179], v[80:83], v[196:199]
    s_waitcnt vmcnt(2) lgkmcnt(0)
    v_mfma_f32_16x16x32_bf16 v[180:183], v[100:103], v[84:87], v[180:183]
    v_add_u32 v7, 81920, v6
    ds_read_b128 v[140:143], v7 offset:0
    v_mfma_f32_16x16x32_bf16 v[184:187], v[104:107], v[84:87], v[184:187]
    ds_read_b128 v[144:147], v7 offset:1024
    v_mfma_f32_16x16x32_bf16 v[188:191], v[108:111], v[84:87], v[188:191]
    ds_read_b128 v[148:151], v7 offset:2048
    v_mfma_f32_16x16x32_bf16 v[192:195], v[112:115], v[84:87], v[192:195]
    ds_read_b128 v[152:155], v7 offset:3072
    v_mfma_f32_16x16x32_bf16 v[196:199], v[116:119], v[84:87], v[196:199]
    ds_read_b128 v[156:159], v7 offset:4096
    ds_read_b128 v[160:163], v7 offset:5120
    v_mfma_f32_16x16x32_bf16 v[180:183], v[120:123], v[88:91], v[180:183]
    ds_read_b128 v[164:167], v7 offset:6144
    v_mfma_f32_16x16x32_bf16 v[184:187], v[124:127], v[88:91], v[184:187]
    ds_read_b128 v[168:171], v7 offset:7168
    v_mfma_f32_16x16x32_bf16 v[188:191], v[128:131], v[88:91], v[188:191]
    ds_read_b128 v[172:175], v7 offset:8192
    v_mfma_f32_16x16x32_bf16 v[192:195], v[132:135], v[88:91], v[192:195]
    ds_read_b128 v[176:179], v7 offset:9216
    v_mfma_f32_16x16x32_bf16 v[196:199], v[136:139], v[88:91], v[196:199]
    s_waitcnt vmcnt(0) lgkmcnt(0)
    v_mfma_f32_16x16x32_bf16 v[180:183], v[140:143], v[92:95], v[180:183]
    v_mfma_f32_16x16x32_bf16 v[184:187], v[144:147], v[92:95], v[184:187]
    v_mfma_f32_16x16x32_bf16 v[188:191], v[148:151], v[92:95], v[188:191]
    v_mfma_f32_16x16x32_bf16 v[192:195], v[152:155], v[92:95], v[192:195]
    v_mfma_f32_16x16x32_bf16 v[196:199], v[156:159], v[92:95], v[196:199]
    v_mfma_f32_16x16x32_bf16 v[180:183], v[160:163], v[96:99], v[180:183]
    v_mfma_f32_16x16x32_bf16 v[184:187], v[164:167], v[96:99], v[184:187]
    v_mfma_f32_16x16x32_bf16 v[188:191], v[168:171], v[96:99], v[188:191]
    v_mfma_f32_16x16x32_bf16 v[192:195], v[172:175], v[96:99], v[192:195]
    v_mfma_f32_16x16x32_bf16 v[196:199], v[176:179], v[96:99], v[196:199]
    s_barrier
    s_cmp_eq_u32 s51, 0
    s_cbranch_scc1 K2_PW0
    s_nop 4
    ds_write_b128 v8, v[180:183] offset:0
    ds_write_b128 v8, v[184:187] offset:1024
    ds_write_b128 v8, v[188:191] offset:2048
    s_waitcnt lgkmcnt(0)
    s_barrier
    ds_read_b128 v[20:23], v11 offset:0
    ds_read_b128 v[24:27], v11 offset:1024
    s_waitcnt lgkmcnt(1)
    v_pk_add_f32 v[20:21], v[20:21], v[192:193]
    v_pk_add_f32 v[22:23], v[22:23], v[194:195]
    v_cvt_pk_bf16_f32 v100, v20, v21
    v_cvt_pk_bf16_f32 v101, v22, v23
    buffer_store_dwordx2 v[100:101], v9, s[68:71], s58 offen offset:96
    s_waitcnt lgkmcnt(0)
    v_pk_add_f32 v[24:25], v[24:25], v[196:197]
    v_pk_add_f32 v[26:27], v[26:27], v[198:199]
    v_cvt_pk_bf16_f32 v102, v24, v25
    v_cvt_pk_bf16_f32 v103, v26, v27
    buffer_store_dwordx2 v[102:103], v9, s[68:71], s58 offen offset:128
    s_branch K2_PFIN
K2_PW0:
    s_nop 4
    ds_write_b128 v8, v[192:195] offset:0
    ds_write_b128 v8, v[196:199] offset:1024
    s_waitcnt lgkmcnt(0)
    s_barrier
    ds_read_b128 v[20:23], v11 offset:0
    ds_read_b128 v[24:27], v11 offset:1024
    ds_read_b128 v[28:31], v11 offset:2048
    s_waitcnt lgkmcnt(2)
    v_pk_add_f32 v[20:21], v[20:21], v[180:181]
    v_pk_add_f32 v[22:23], v[22:23], v[182:183]
    v_cvt_pk_bf16_f32 v100, v20, v21
    v_cvt_pk_bf16_f32 v101, v22, v23
    buffer_store_dwordx2 v[100:101], v9, s[68:71], s58 offen offset:0
    s_waitcnt lgkmcnt(1)
    v_pk_add_f32 v[24:25], v[24:25], v[184:185]
    v_pk_add_f32 v[26:27], v[26:27], v[186:187]
    v_cvt_pk_bf16_f32 v102, v24, v25
    v_cvt_pk_bf16_f32 v103, v26, v27
    buffer_store_dwordx2 v[102:103], v9, s[68:71], s58 offen offset:32
    s_waitcnt lgkmcnt(0)
    v_pk_add_f32 v[28:29], v[28:29], v[188:189]
    v_pk_add_f32 v[30:31], v[30:31], v[190:191]
    v_cvt_pk_bf16_f32 v104, v28, v29
    v_cvt_pk_bf16_f32 v105, v30, v31
    buffer_store_dwordx2 v[104:105], v9, s[68:71], s58 offen offset:64
K2_PFIN:
    s_endpgm
K2_REDO:
    s_waitcnt vmcnt(0) lgkmcnt(0)
    s_barrier
    s_mov_b32 s29, 0
    s_add_u32 m0, s44, s29
    s_add_u32 s19, m0, s28
    buffer_load_dwordx4 v2, s[8:11], s19 offen lds
    s_add_u32 m0, s45, s29
    s_add_u32 s19, m0, s28
    buffer_load_dwordx4 v2, s[8:11], s19 offen lds
    s_add_u32 m0, s46, s29
    s_add_u32 s19, m0, s28
    buffer_load_dwordx4 v2, s[8:11], s19 offen lds
    s_add_u32 m0, s47, s29
    s_add_u32 s19, m0, s28
    buffer_load_dwordx4 v2, s[8:11], s19 offen lds
    s_add_u32 m0, s48, s29
    s_add_u32 s19, m0, s28
    buffer_load_dwordx4 v2, s[8:11], s19 offen lds
    s_add_u32 s29, s29, 20480
    s_add_u32 m0, s44, s29
    s_add_u32 s19, m0, s28
    buffer_load_dwordx4 v2, s[8:11], s19 offen lds
    s_add_u32 m0, s45, s29
    s_add_u32 s19, m0, s28
    buffer_load_dwordx4 v2, s[8:11], s19 offen lds
    s_add_u32 m0, s46, s29
    s_add_u32 s19, m0, s28
    buffer_load_dwordx4 v2, s[8:11], s19 offen lds
    s_add_u32 m0, s47, s29
    s_add_u32 s19, m0, s28
    buffer_load_dwordx4 v2, s[8:11], s19 offen lds
    s_add_u32 m0, s48, s29
    s_add_u32 s19, m0, s28
    buffer_load_dwordx4 v2, s[8:11], s19 offen lds
    s_add_u32 s29, s29, 20480
    s_add_u32 m0, s44, s29
    s_add_u32 s19, m0, s28
    buffer_load_dwordx4 v2, s[8:11], s19 offen lds
    s_add_u32 m0, s45, s29
    s_add_u32 s19, m0, s28
    buffer_load_dwordx4 v2, s[8:11], s19 offen lds
    s_add_u32 m0, s46, s29
    s_add_u32 s19, m0, s28
    buffer_load_dwordx4 v2, s[8:11], s19 offen lds
    s_add_u32 m0, s47, s29
    s_add_u32 s19, m0, s28
    buffer_load_dwordx4 v2, s[8:11], s19 offen lds
    s_add_u32 m0, s48, s29
    s_add_u32 s19, m0, s28
    buffer_load_dwordx4 v2, s[8:11], s19 offen lds
    s_add_u32 s29, s29, 20480
    s_add_u32 m0, s44, s29
    s_add_u32 s19, m0, s28
    buffer_load_dwordx4 v2, s[8:11], s19 offen lds
    s_add_u32 m0, s45, s29
    s_add_u32 s19, m0, s28
    buffer_load_dwordx4 v2, s[8:11], s19 offen lds
    s_add_u32 m0, s46, s29
    s_add_u32 s19, m0, s28
    buffer_load_dwordx4 v2, s[8:11], s19 offen lds
    s_add_u32 m0, s47, s29
    s_add_u32 s19, m0, s28
    buffer_load_dwordx4 v2, s[8:11], s19 offen lds
    s_add_u32 m0, s48, s29
    s_add_u32 s19, m0, s28
    buffer_load_dwordx4 v2, s[8:11], s19 offen lds
    s_add_u32 s29, s29, 20480
    s_mov_b32 s21, 1
    s_mov_b32 s66, 99
    v_mov_b32 v8, 0xff61b1e6
    v_mov_b32 v10, 0xff61b1e6
    v_add_u32 v5, s37, v23
    v_add_u32 v6, 1280, v5
    v_add_u32 v7, s37, v3
    v_add_u32 v17, s37, v4
    v_add_u32 v17, 10240, v17
    s_mov_b32 s20, 0
    s_waitcnt vmcnt(0)
    s_barrier
K2_MAXLOOP:
    ds_read2st64_b64 v[44:47], v5 offset0:0 offset1:1
    ds_read_b64 v[52:53], v7 offset:1024
    s_waitcnt lgkmcnt(0)
    v_mfma_f32_32x32x16_bf16 v[84:99], v[44:47], v[24:27], 0
    v_mfma_f32_32x32x8_bf16 v[84:99], v[52:53], v[32:33], v[84:99]
    v_mfma_f32_32x32x16_bf16 v[100:115], v[44:47], v[28:31], 0
    v_mfma_f32_32x32x8_bf16 v[100:115], v[52:53], v[34:35], v[100:115]
    s_nop 15
    v_max3_f32 v8, v8, v84, v85
    v_max3_f32 v8, v8, v86, v87
    v_max3_f32 v8, v8, v88, v89
    v_max3_f32 v8, v8, v90, v91
    v_max3_f32 v8, v8, v92, v93
    v_max3_f32 v8, v8, v94, v95
    v_max3_f32 v8, v8, v96, v97
    v_max3_f32 v8, v8, v98, v99
    v_max3_f32 v10, v10, v100, v101
    v_max3_f32 v10, v10, v102, v103
    v_max3_f32 v10, v10, v104, v105
    v_max3_f32 v10, v10, v106, v107
    v_max3_f32 v10, v10, v108, v109
    v_max3_f32 v10, v10, v110, v111
    v_max3_f32 v10, v10, v112, v113
    v_max3_f32 v10, v10, v114, v115
    ds_read2st64_b64 v[44:47], v6 offset0:0 offset1:1
    ds_read_b64 v[52:53], v7 offset:2304
    s_waitcnt lgkmcnt(0)
    v_mfma_f32_32x32x16_bf16 v[84:99], v[44:47], v[24:27], 0
    v_mfma_f32_32x32x8_bf16 v[84:99], v[52:53], v[32:33], v[84:99]
    v_mfma_f32_32x32x16_bf16 v[100:115], v[44:47], v[28:31], 0
    v_mfma_f32_32x32x8_bf16 v[100:115], v[52:53], v[34:35], v[100:115]
    s_nop 15
    v_max3_f32 v8, v8, v84, v85
    v_max3_f32 v8, v8, v86, v87
    v_max3_f32 v8, v8, v88, v89
    v_max3_f32 v8, v8, v90, v91
    v_max3_f32 v8, v8, v92, v93
    v_max3_f32 v8, v8, v94, v95
    v_max3_f32 v8, v8, v96, v97
    v_max3_f32 v8, v8, v98, v99
    v_max3_f32 v10, v10, v100, v101
    v_max3_f32 v10, v10, v102, v103
    v_max3_f32 v10, v10, v104, v105
    v_max3_f32 v10, v10, v106, v107
    v_max3_f32 v10, v10, v108, v109
    v_max3_f32 v10, v10, v110, v111
    v_max3_f32 v10, v10, v112, v113
    v_max3_f32 v10, v10, v114, v115
    ds_read2st64_b64 v[44:47], v5 offset0:5 offset1:6
    ds_read_b64 v[52:53], v7 offset:3584
    s_waitcnt lgkmcnt(0)
    v_mfma_f32_32x32x16_bf16 v[84:99], v[44:47], v[24:27], 0
    v_mfma_f32_32x32x8_bf16 v[84:99], v[52:53], v[32:33], v[84:99]
    v_mfma_f32_32x32x16_bf16 v[100:115], v[44:47], v[28:31], 0
    v_mfma_f32_32x32x8_bf16 v[100:115], v[52:53], v[34:35], v[100:115]
    s_nop 15
    v_max3_f32 v8, v8, v84, v85
    v_max3_f32 v8, v8, v86, v87
    v_max3_f32 v8, v8, v88, v89
    v_max3_f32 v8, v8, v90, v91
    v_max3_f32 v8, v8, v92, v93
    v_max3_f32 v8, v8, v94, v95
    v_max3_f32 v8, v8, v96, v97
    v_max3_f32 v8, v8, v98, v99
    v_max3_f32 v10, v10, v100, v101
    v_max3_f32 v10, v10, v102, v103
    v_max3_f32 v10, v10, v104, v105
    v_max3_f32 v10, v10, v106, v107
    v_max3_f32 v10, v10, v108, v109
    v_max3_f32 v10, v10, v110, v111
    v_max3_f32 v10, v10, v112, v113
    v_max3_f32 v10, v10, v114, v115
    ds_read2st64_b64 v[44:47], v6 offset0:5 offset1:6
    ds_read_b64 v[52:53], v7 offset:4864
    s_waitcnt lgkmcnt(0)
    v_mfma_f32_32x32x16_bf16 v[84:99], v[44:47], v[24:27], 0
    v_mfma_f32_32x32x8_bf16 v[84:99], v[52:53], v[32:33], v[84:99]
    v_mfma_f32_32x32x16_bf16 v[100:115], v[44:47], v[28:31], 0
    v_mfma_f32_32x32x8_bf16 v[100:115], v[52:53], v[34:35], v[100:115]
    s_nop 15
    v_max3_f32 v8, v8, v84, v85
    v_max3_f32 v8, v8, v86, v87
    v_max3_f32 v8, v8, v88, v89
    v_max3_f32 v8, v8, v90, v91
    v_max3_f32 v8, v8, v92, v93
    v_max3_f32 v8, v8, v94, v95
    v_max3_f32 v8, v8, v96, v97
    v_max3_f32 v8, v8, v98, v99
    v_max3_f32 v10, v10, v100, v101
    v_max3_f32 v10, v10, v102, v103
    v_max3_f32 v10, v10, v104, v105
    v_max3_f32 v10, v10, v106, v107
    v_max3_f32 v10, v10, v108, v109
    v_max3_f32 v10, v10, v110, v111
    v_max3_f32 v10, v10, v112, v113
    v_max3_f32 v10, v10, v114, v115
    ds_read2st64_b64 v[44:47], v5 offset0:10 offset1:11
    ds_read_b64 v[52:53], v7 offset:6144
    s_waitcnt lgkmcnt(0)
    v_mfma_f32_32x32x16_bf16 v[84:99], v[44:47], v[24:27], 0
    v_mfma_f32_32x32x8_bf16 v[84:99], v[52:53], v[32:33], v[84:99]
    v_mfma_f32_32x32x16_bf16 v[100:115], v[44:47], v[28:31], 0
    v_mfma_f32_32x32x8_bf16 v[100:115], v[52:53], v[34:35], v[100:115]
    s_nop 15
    v_max3_f32 v8, v8, v84, v85
    v_max3_f32 v8, v8, v86, v87
    v_max3_f32 v8, v8, v88, v89
    v_max3_f32 v8, v8, v90, v91
    v_max3_f32 v8, v8, v92, v93
    v_max3_f32 v8, v8, v94, v95
    v_max3_f32 v8, v8, v96, v97
    v_max3_f32 v8, v8, v98, v99
    v_max3_f32 v10, v10, v100, v101
    v_max3_f32 v10, v10, v102, v103
    v_max3_f32 v10, v10, v104, v105
    v_max3_f32 v10, v10, v106, v107
    v_max3_f32 v10, v10, v108, v109
    v_max3_f32 v10, v10, v110, v111
    v_max3_f32 v10, v10, v112, v113
    v_max3_f32 v10, v10, v114, v115
    ds_read2st64_b64 v[44:47], v6 offset0:10 offset1:11
    ds_read_b64 v[52:53], v7 offset:7424
    s_waitcnt lgkmcnt(0)
    v_mfma_f32_32x32x16_bf16 v[84:99], v[44:47], v[24:27], 0
    v_mfma_f32_32x32x8_bf16 v[84:99], v[52:53], v[32:33], v[84:99]
    v_mfma_f32_32x32x16_bf16 v[100:115], v[44:47], v[28:31], 0
    v_mfma_f32_32x32x8_bf16 v[100:115], v[52:53], v[34:35], v[100:115]
    s_nop 15
    v_max3_f32 v8, v8, v84, v85
    v_max3_f32 v8, v8, v86, v87
    v_max3_f32 v8, v8, v88, v89
    v_max3_f32 v8, v8, v90, v91
    v_max3_f32 v8, v8, v92, v93
    v_max3_f32 v8, v8, v94, v95
    v_max3_f32 v8, v8, v96, v97
    v_max3_f32 v8, v8, v98, v99
    v_max3_f32 v10, v10, v100, v101
    v_max3_f32 v10, v10, v102, v103
    v_max3_f32 v10, v10, v104, v105
    v_max3_f32 v10, v10, v106, v107
    v_max3_f32 v10, v10, v108, v109
    v_max3_f32 v10, v10, v110, v111
    v_max3_f32 v10, v10, v112, v113
    v_max3_f32 v10, v10, v114, v115
    ds_read2st64_b64 v[44:47], v5 offset0:15 offset1:16
    ds_read_b64 v[52:53], v7 offset:8704
    s_waitcnt lgkmcnt(0)
    v_mfma_f32_32x32x16_bf16 v[84:99], v[44:47], v[24:27], 0
    v_mfma_f32_32x32x8_bf16 v[84:99], v[52:53], v[32:33], v[84:99]
    v_mfma_f32_32x32x16_bf16 v[100:115], v[44:47], v[28:31], 0
    v_mfma_f32_32x32x8_bf16 v[100:115], v[52:53], v[34:35], v[100:115]
    s_nop 15
    v_max3_f32 v8, v8, v84, v85
    v_max3_f32 v8, v8, v86, v87
    v_max3_f32 v8, v8, v88, v89
    v_max3_f32 v8, v8, v90, v91
    v_max3_f32 v8, v8, v92, v93
    v_max3_f32 v8, v8, v94, v95
    v_max3_f32 v8, v8, v96, v97
    v_max3_f32 v8, v8, v98, v99
    v_max3_f32 v10, v10, v100, v101
    v_max3_f32 v10, v10, v102, v103
    v_max3_f32 v10, v10, v104, v105
    v_max3_f32 v10, v10, v106, v107
    v_max3_f32 v10, v10, v108, v109
    v_max3_f32 v10, v10, v110, v111
    v_max3_f32 v10, v10, v112, v113
    v_max3_f32 v10, v10, v114, v115
    ds_read2st64_b64 v[44:47], v6 offset0:15 offset1:16
    ds_read_b64 v[52:53], v7 offset:9984
    s_waitcnt lgkmcnt(0)
    v_mfma_f32_32x32x16_bf16 v[84:99], v[44:47], v[24:27], 0
    v_mfma_f32_32x32x8_bf16 v[84:99], v[52:53], v[32:33], v[84:99]
    v_mfma_f32_32x32x16_bf16 v[100:115], v[44:47], v[28:31], 0
    v_mfma_f32_32x32x8_bf16 v[100:115], v[52:53], v[34:35], v[100:115]
    s_nop 15
    v_max3_f32 v8, v8, v84, v85
    v_max3_f32 v8, v8, v86, v87
    v_max3_f32 v8, v8, v88, v89
    v_max3_f32 v8, v8, v90, v91
    v_max3_f32 v8, v8, v92, v93
    v_max3_f32 v8, v8, v94, v95
    v_max3_f32 v8, v8, v96, v97
    v_max3_f32 v8, v8, v98, v99
    v_max3_f32 v10, v10, v100, v101
    v_max3_f32 v10, v10, v102, v103
    v_max3_f32 v10, v10, v104, v105
    v_max3_f32 v10, v10, v106, v107
    v_max3_f32 v10, v10, v108, v109
    v_max3_f32 v10, v10, v110, v111
    v_max3_f32 v10, v10, v112, v113
    v_max3_f32 v10, v10, v114, v115
    v_add_u32 v5, 20480, v5
    v_add_u32 v6, 20480, v6
    v_add_u32 v7, 20480, v7
    s_add_u32 s20, s20, 1
    s_cmp_lt_u32 s20, 4
    s_cbranch_scc1 K2_MAXLOOP
    v_mov_b32 v9, v8
    v_mov_b32 v11, v10
    s_nop 1
    v_permlane32_swap_b32 v8, v9
    v_permlane32_swap_b32 v10, v11
    s_nop 1
    v_max_f32 v8, v8, v9
    v_sub_f32 v116, 0, v8
    v_mov_b32 v148, 0
    v_sub_f32 v117, 0, v8
    v_mov_b32 v149, 0
    v_sub_f32 v118, 0, v8
    v_mov_b32 v150, 0
    v_sub_f32 v119, 0, v8
    v_mov_b32 v151, 0
    v_sub_f32 v120, 0, v8
    v_mov_b32 v152, 0
    v_sub_f32 v121, 0, v8
    v_mov_b32 v153, 0
    v_sub_f32 v122, 0, v8
    v_mov_b32 v154, 0
    v_sub_f32 v123, 0, v8
    v_mov_b32 v155, 0
    v_sub_f32 v124, 0, v8
    v_mov_b32 v156, 0
    v_sub_f32 v125, 0, v8
    v_mov_b32 v157, 0
    v_sub_f32 v126, 0, v8
    v_mov_b32 v158, 0
    v_sub_f32 v127, 0, v8
    v_mov_b32 v159, 0
    v_sub_f32 v128, 0, v8
    v_mov_b32 v160, 0
    v_sub_f32 v129, 0, v8
    v_mov_b32 v161, 0
    v_sub_f32 v130, 0, v8
    v_mov_b32 v162, 0
    v_sub_f32 v131, 0, v8
    v_mov_b32 v163, 0
    v_max_f32 v10, v10, v11
    v_sub_f32 v132, 0, v10
    v_mov_b32 v164, 0
    v_sub_f32 v133, 0, v10
    v_mov_b32 v165, 0
    v_sub_f32 v134, 0, v10
    v_mov_b32 v166, 0
    v_sub_f32 v135, 0, v10
    v_mov_b32 v167, 0
    v_sub_f32 v136, 0, v10
    v_mov_b32 v168, 0
    v_sub_f32 v137, 0, v10
    v_mov_b32 v169, 0
    v_sub_f32 v138, 0, v10
    v_mov_b32 v170, 0
    v_sub_f32 v139, 0, v10
    v_mov_b32 v171, 0
    v_sub_f32 v140, 0, v10
    v_mov_b32 v172, 0
    v_sub_f32 v141, 0, v10
    v_mov_b32 v173, 0
    v_sub_f32 v142, 0, v10
    v_mov_b32 v174, 0
    v_sub_f32 v143, 0, v10
    v_mov_b32 v175, 0
    v_sub_f32 v144, 0, v10
    v_mov_b32 v176, 0
    v_sub_f32 v145, 0, v10
    v_mov_b32 v177, 0
    v_sub_f32 v146, 0, v10
    v_mov_b32 v178, 0
    v_sub_f32 v147, 0, v10
    v_mov_b32 v179, 0
    v_mov_b32 v76, 0
    v_mov_b32 v77, 0
    v_mov_b32 v78, 0
    v_mov_b32 v79, 0
    s_branch K2_START
K2_RLOOP:
    v_mfma_f32_32x32x16_bf16 v[100:115], v[44:47], v[28:31], v[132:147]
    ds_read2st64_b64 v[48:51], v6 offset0:0 offset1:1
    ds_read_b64 v[54:55], v7 offset:2304
    v_exp_f32 v84, v84
    v_exp_f32 v85, v85
    v_exp_f32 v86, v86
    v_exp_f32 v87, v87
    v_mfma_f32_32x32x16_bf16 v[164:179], v[68:71], v[76:79], v[164:179]
    s_mov_b64 exec, s[22:23]
    ds_read_b128 v[64:67], v17 offset:640
    ds_read_b128 v[60:63], v17 offset:1280
    s_mov_b64 exec, -1
    v_exp_f32 v88, v88
    v_exp_f32 v89, v89
    v_exp_f32 v90, v90
    v_exp_f32 v91, v91
    v_cvt_pk_bf16_f32 v72, v84, v85
    v_cvt_pk_bf16_f32 v73, v86, v87
    v_cvt_pk_bf16_f32 v74, v88, v89
    v_cvt_pk_bf16_f32 v75, v90, v91
    v_mfma_f32_32x32x8_bf16 v[100:115], v[52:53], v[34:35], v[100:115]
    v_exp_f32 v92, v92
    v_exp_f32 v93, v93
    v_exp_f32 v94, v94
    v_exp_f32 v95, v95
    v_mfma_f32_32x32x16_bf16 v[148:163], v[56:59], v[72:75], v[148:163]
    v_exp_f32 v96, v96
    v_exp_f32 v97, v97
    v_exp_f32 v98, v98
    v_exp_f32 v99, v99
    v_cvt_pk_bf16_f32 v76, v92, v93
    v_cvt_pk_bf16_f32 v77, v94, v95
    v_cvt_pk_bf16_f32 v78, v96, v97
    v_cvt_pk_bf16_f32 v79, v98, v99
    s_waitcnt lgkmcnt(0)
    v_mfma_f32_32x32x16_bf16 v[84:99], v[48:51], v[24:27], v[116:131]
    v_exp_f32 v100, v100
    v_exp_f32 v101, v101
    v_exp_f32 v102, v102
    v_exp_f32 v103, v103
    v_mfma_f32_32x32x16_bf16 v[148:163], v[64:67], v[76:79], v[148:163]
    v_exp_f32 v104, v104
    v_exp_f32 v105, v105
    v_exp_f32 v106, v106
    v_exp_f32 v107, v107
    v_cvt_pk_bf16_f32 v72, v100, v101
    v_cvt_pk_bf16_f32 v73, v102, v103
    v_cvt_pk_bf16_f32 v74, v104, v105
    v_cvt_pk_bf16_f32 v75, v106, v107
    v_mfma_f32_32x32x8_bf16 v[84:99], v[54:55], v[32:33], v[84:99]
    v_exp_f32 v108, v108
    v_exp_f32 v109, v109
    v_exp_f32 v110, v110
    v_exp_f32 v111, v111
    v_mfma_f32_32x32x16_bf16 v[164:179], v[56:59], v[72:75], v[164:179]
    v_exp_f32 v112, v112
    v_exp_f32 v113, v113
    v_exp_f32 v114, v114
    v_exp_f32 v115, v115
    v_cvt_pk_bf16_f32 v76, v108, v109
    v_cvt_pk_bf16_f32 v77, v110, v111
    v_cvt_pk_bf16_f32 v78, v112, v113
    v_cvt_pk_bf16_f32 v79, v114, v115
    v_mfma_f32_32x32x16_bf16 v[100:115], v[48:51], v[28:31], v[132:147]
    ds_read2st64_b64 v[44:47], v5 offset0:5 offset1:6
    ds_read_b64 v[52:53], v7 offset:3584
    v_exp_f32 v84, v84
    v_exp_f32 v85, v85
    v_exp_f32 v86, v86
    v_exp_f32 v87, v87
    v_mfma_f32_32x32x16_bf16 v[164:179], v[64:67], v[76:79], v[164:179]
    s_mov_b64 exec, s[22:23]
    ds_read_b128 v[68:71], v17 offset:1920
    ds_read_b128 v[56:59], v17 offset:2560
    s_mov_b64 exec, -1
    v_exp_f32 v88, v88
    v_exp_f32 v89, v89
    v_exp_f32 v90, v90
    v_exp_f32 v91, v91
    v_cvt_pk_bf16_f32 v72, v84, v85
    v_cvt_pk_bf16_f32 v73, v86, v87
    v_cvt_pk_bf16_f32 v74, v88, v89
    v_cvt_pk_bf16_f32 v75, v90, v91
    v_mfma_f32_32x32x8_bf16 v[100:115], v[54:55], v[34:35], v[100:115]
    v_exp_f32 v92, v92
    v_exp_f32 v93, v93
    v_exp_f32 v94, v94
    v_exp_f32 v95, v95
    v_mfma_f32_32x32x16_bf16 v[148:163], v[60:63], v[72:75], v[148:163]
    v_exp_f32 v96, v96
    v_exp_f32 v97, v97
    v_exp_f32 v98, v98
    v_exp_f32 v99, v99
    v_cvt_pk_bf16_f32 v76, v92, v93
    v_cvt_pk_bf16_f32 v77, v94, v95
    v_cvt_pk_bf16_f32 v78, v96, v97
    v_cvt_pk_bf16_f32 v79, v98, v99
    s_waitcnt lgkmcnt(0)
    v_mfma_f32_32x32x16_bf16 v[84:99], v[44:47], v[24:27], v[116:131]
    v_exp_f32 v100, v100
    v_exp_f32 v101, v101
    v_exp_f32 v102, v102
    v_exp_f32 v103, v103
    v_mfma_f32_32x32x16_bf16 v[148:163], v[68:71], v[76:79], v[148:163]
    v_exp_f32 v104, v104
    v_exp_f32 v105, v105
    v_exp_f32 v106, v106
    v_exp_f32 v107, v107
    v_cvt_pk_bf16_f32 v72, v100, v101
    v_cvt_pk_bf16_f32 v73, v102, v103
    v_cvt_pk_bf16_f32 v74, v104, v105
    v_cvt_pk_bf16_f32 v75, v106, v107
    v_mfma_f32_32x32x8_bf16 v[84:99], v[52:53], v[32:33], v[84:99]
    v_exp_f32 v108, v108
    v_exp_f32 v109, v109
    v_exp_f32 v110, v110
    v_exp_f32 v111, v111
    v_mfma_f32_32x32x16_bf16 v[164:179], v[60:63], v[72:75], v[164:179]
    v_exp_f32 v112, v112
    v_exp_f32 v113, v113
    v_exp_f32 v114, v114
    v_exp_f32 v115, v115
    v_cvt_pk_bf16_f32 v76, v108, v109
    v_cvt_pk_bf16_f32 v77, v110, v111
    v_cvt_pk_bf16_f32 v78, v112, v113
    v_cvt_pk_bf16_f32 v79, v114, v115
    v_mfma_f32_32x32x16_bf16 v[100:115], v[44:47], v[28:31], v[132:147]
    ds_read2st64_b64 v[48:51], v6 offset0:5 offset1:6
    ds_read_b64 v[54:55], v7 offset:4864
    v_exp_f32 v84, v84
    v_exp_f32 v85, v85
    v_exp_f32 v86, v86
    v_exp_f32 v87, v87
    v_mfma_f32_32x32x16_bf16 v[164:179], v[68:71], v[76:79], v[164:179]
    s_mov_b64 exec, s[22:23]
    ds_read_b128 v[64:67], v17 offset:3200
    ds_read_b128 v[60:63], v17 offset:3840
    s_mov_b64 exec, -1
    v_exp_f32 v88, v88
    v_exp_f32 v89, v89
    v_exp_f32 v90, v90
    v_exp_f32 v91, v91
    v_cvt_pk_bf16_f32 v72, v84, v85
    v_cvt_pk_bf16_f32 v73, v86, v87
    v_cvt_pk_bf16_f32 v74, v88, v89
    v_cvt_pk_bf16_f32 v75, v90, v91
    v_mfma_f32_32x32x8_bf16 v[100:115], v[52:53], v[34:35], v[100:115]
    v_exp_f32 v92, v92
    v_exp_f32 v93, v93
    v_exp_f32 v94, v94
    v_exp_f32 v95, v95
    v_mfma_f32_32x32x16_bf16 v[148:163], v[56:59], v[72:75], v[148:163]
    v_exp_f32 v96, v96
    v_exp_f32 v97, v97
    v_exp_f32 v98, v98
    v_exp_f32 v99, v99
    v_cvt_pk_bf16_f32 v76, v92, v93
    v_cvt_pk_bf16_f32 v77, v94, v95
    v_cvt_pk_bf16_f32 v78, v96, v97
    v_cvt_pk_bf16_f32 v79, v98, v99
    s_waitcnt lgkmcnt(0)
    v_mfma_f32_32x32x16_bf16 v[84:99], v[48:51], v[24:27], v[116:131]
    v_exp_f32 v100, v100
    v_exp_f32 v101, v101
    v_exp_f32 v102, v102
    v_exp_f32 v103, v103
    v_mfma_f32_32x32x16_bf16 v[148:163], v[64:67], v[76:79], v[148:163]
    v_exp_f32 v104, v104
    v_exp_f32 v105, v105
    v_exp_f32 v106, v106
    v_exp_f32 v107, v107
    v_cvt_pk_bf16_f32 v72, v100, v101
    v_cvt_pk_bf16_f32 v73, v102, v103
    v_cvt_pk_bf16_f32 v74, v104, v105
    v_cvt_pk_bf16_f32 v75, v106, v107
    v_mfma_f32_32x32x8_bf16 v[84:99], v[54:55], v[32:33], v[84:99]
    v_exp_f32 v108, v108
    v_exp_f32 v109, v109
    v_exp_f32 v110, v110
    v_exp_f32 v111, v111
    v_mfma_f32_32x32x16_bf16 v[164:179], v[56:59], v[72:75], v[164:179]
    v_exp_f32 v112, v112
    v_exp_f32 v113, v113
    v_exp_f32 v114, v114
    v_exp_f32 v115, v115
    v_cvt_pk_bf16_f32 v76, v108, v109
    v_cvt_pk_bf16_f32 v77, v110, v111
    v_cvt_pk_bf16_f32 v78, v112, v113
    v_cvt_pk_bf16_f32 v79, v114, v115
    v_mfma_f32_32x32x16_bf16 v[100:115], v[48:51], v[28:31], v[132:147]
    ds_read2st64_b64 v[44:47], v5 offset0:10 offset1:11
    ds_read_b64 v[52:53], v7 offset:6144
    v_exp_f32 v84, v84
    v_exp_f32 v85, v85
    v_exp_f32 v86, v86
    v_exp_f32 v87, v87
    v_mfma_f32_32x32x16_bf16 v[164:179], v[64:67], v[76:79], v[164:179]
    s_mov_b64 exec, s[22:23]
    ds_read_b128 v[68:71], v17 offset:4480
    ds_read_b128 v[56:59], v17 offset:5120
    s_mov_b64 exec, -1
    v_exp_f32 v88, v88
    v_exp_f32 v89, v89
    v_exp_f32 v90, v90
    v_exp_f32 v91, v91
    v_cvt_pk_bf16_f32 v72, v84, v85
    v_cvt_pk_bf16_f32 v73, v86, v87
    v_cvt_pk_bf16_f32 v74, v88, v89
    v_cvt_pk_bf16_f32 v75, v90, v91
    v_mfma_f32_32x32x8_bf16 v[100:115], v[54:55], v[34:35], v[100:115]
    v_exp_f32 v92, v92
    v_exp_f32 v93, v93
    v_exp_f32 v94, v94
    v_exp_f32 v95, v95
    v_mfma_f32_32x32x16_bf16 v[148:163], v[60:63], v[72:75], v[148:163]
    v_exp_f32 v96, v96
    v_exp_f32 v97, v97
    v_exp_f32 v98, v98
    v_exp_f32 v99, v99
    v_cvt_pk_bf16_f32 v76, v92, v93
    v_cvt_pk_bf16_f32 v77, v94, v95
    v_cvt_pk_bf16_f32 v78, v96, v97
    v_cvt_pk_bf16_f32 v79, v98, v99
    s_waitcnt lgkmcnt(0)
    v_mfma_f32_32x32x16_bf16 v[84:99], v[44:47], v[24:27], v[116:131]
    v_exp_f32 v100, v100
    v_exp_f32 v101, v101
    v_exp_f32 v102, v102
    v_exp_f32 v103, v103
    v_mfma_f32_32x32x16_bf16 v[148:163], v[68:71], v[76:79], v[148:163]
    v_exp_f32 v104, v104
    v_exp_f32 v105, v105
    v_exp_f32 v106, v106
    v_exp_f32 v107, v107
    v_cvt_pk_bf16_f32 v72, v100, v101
    v_cvt_pk_bf16_f32 v73, v102, v103
    v_cvt_pk_bf16_f32 v74, v104, v105
    v_cvt_pk_bf16_f32 v75, v106, v107
    v_mfma_f32_32x32x8_bf16 v[84:99], v[52:53], v[32:33], v[84:99]
    v_exp_f32 v108, v108
    v_exp_f32 v109, v109
    v_exp_f32 v110, v110
    v_exp_f32 v111, v111
    v_mfma_f32_32x32x16_bf16 v[164:179], v[60:63], v[72:75], v[164:179]
    v_exp_f32 v112, v112
    v_exp_f32 v113, v113
    v_exp_f32 v114, v114
    v_exp_f32 v115, v115
    v_cvt_pk_bf16_f32 v76, v108, v109
    v_cvt_pk_bf16_f32 v77, v110, v111
    v_cvt_pk_bf16_f32 v78, v112, v113
    v_cvt_pk_bf16_f32 v79, v114, v115
    v_mfma_f32_32x32x16_bf16 v[100:115], v[44:47], v[28:31], v[132:147]
    ds_read2st64_b64 v[48:51], v6 offset0:10 offset1:11
    ds_read_b64 v[54:55], v7 offset:7424
    v_exp_f32 v84, v84
    v_exp_f32 v85, v85
    v_exp_f32 v86, v86
    v_exp_f32 v87, v87
    v_mfma_f32_32x32x16_bf16 v[164:179], v[68:71], v[76:79], v[164:179]
    s_mov_b64 exec, s[22:23]
    ds_read_b128 v[64:67], v17 offset:5760
    ds_read_b128 v[60:63], v17 offset:6400
    s_mov_b64 exec, -1
    v_exp_f32 v88, v88
    v_exp_f32 v89, v89
    v_exp_f32 v90, v90
    v_exp_f32 v91, v91
    v_cvt_pk_bf16_f32 v72, v84, v85
    v_cvt_pk_bf16_f32 v73, v86, v87
    v_cvt_pk_bf16_f32 v74, v88, v89
    v_cvt_pk_bf16_f32 v75, v90, v91
    v_mfma_f32_32x32x8_bf16 v[100:115], v[52:53], v[34:35], v[100:115]
    v_exp_f32 v92, v92
    v_exp_f32 v93, v93
    v_exp_f32 v94, v94
    v_exp_f32 v95, v95
    v_mfma_f32_32x32x16_bf16 v[148:163], v[56:59], v[72:75], v[148:163]
    v_exp_f32 v96, v96
    v_exp_f32 v97, v97
    v_exp_f32 v98, v98
    v_exp_f32 v99, v99
    v_cvt_pk_bf16_f32 v76, v92, v93
    v_cvt_pk_bf16_f32 v77, v94, v95
    v_cvt_pk_bf16_f32 v78, v96, v97
    v_cvt_pk_bf16_f32 v79, v98, v99
    s_waitcnt lgkmcnt(0)
    v_mfma_f32_32x32x16_bf16 v[84:99], v[48:51], v[24:27], v[116:131]
    v_exp_f32 v100, v100
    v_exp_f32 v101, v101
    v_exp_f32 v102, v102
    v_exp_f32 v103, v103
    v_mfma_f32_32x32x16_bf16 v[148:163], v[64:67], v[76:79], v[148:163]
    v_exp_f32 v104, v104
    v_exp_f32 v105, v105
    v_exp_f32 v106, v106
    v_exp_f32 v107, v107
    v_cvt_pk_bf16_f32 v72, v100, v101
    v_cvt_pk_bf16_f32 v73, v102, v103
    v_cvt_pk_bf16_f32 v74, v104, v105
    v_cvt_pk_bf16_f32 v75, v106, v107
    v_mfma_f32_32x32x8_bf16 v[84:99], v[54:55], v[32:33], v[84:99]
    v_exp_f32 v108, v108
    v_exp_f32 v109, v109
    v_exp_f32 v110, v110
    v_exp_f32 v111, v111
    v_mfma_f32_32x32x16_bf16 v[164:179], v[56:59], v[72:75], v[164:179]
    v_exp_f32 v112, v112
    v_exp_f32 v113, v113
    v_exp_f32 v114, v114
    v_exp_f32 v115, v115
    v_cvt_pk_bf16_f32 v76, v108, v109
    v_cvt_pk_bf16_f32 v77, v110, v111
    v_cvt_pk_bf16_f32 v78, v112, v113
    v_cvt_pk_bf16_f32 v79, v114, v115
    v_mfma_f32_32x32x16_bf16 v[100:115], v[48:51], v[28:31], v[132:147]
    ds_read2st64_b64 v[44:47], v5 offset0:15 offset1:16
    ds_read_b64 v[52:53], v7 offset:8704
    v_exp_f32 v84, v84
    v_exp_f32 v85, v85
    v_exp_f32 v86, v86
    v_exp_f32 v87, v87
    v_mfma_f32_32x32x16_bf16 v[164:179], v[64:67], v[76:79], v[164:179]
    s_mov_b64 exec, s[22:23]
    ds_read_b128 v[68:71], v17 offset:7040
    ds_read_b128 v[56:59], v17 offset:7680
    s_mov_b64 exec, -1
    v_exp_f32 v88, v88
    v_exp_f32 v89, v89
    v_exp_f32 v90, v90
    v_exp_f32 v91, v91
    v_cvt_pk_bf16_f32 v72, v84, v85
    v_cvt_pk_bf16_f32 v73, v86, v87
    v_cvt_pk_bf16_f32 v74, v88, v89
    v_cvt_pk_bf16_f32 v75, v90, v91
    v_mfma_f32_32x32x8_bf16 v[100:115], v[54:55], v[34:35], v[100:115]
    v_exp_f32 v92, v92
    v_exp_f32 v93, v93
    v_exp_f32 v94, v94
    v_exp_f32 v95, v95
    v_mfma_f32_32x32x16_bf16 v[148:163], v[60:63], v[72:75], v[148:163]
    v_exp_f32 v96, v96
    v_exp_f32 v97, v97
    v_exp_f32 v98, v98
    v_exp_f32 v99, v99
    v_cvt_pk_bf16_f32 v76, v92, v93
    v_cvt_pk_bf16_f32 v77, v94, v95
    v_cvt_pk_bf16_f32 v78, v96, v97
    v_cvt_pk_bf16_f32 v79, v98, v99
    s_waitcnt lgkmcnt(0)
    v_mfma_f32_32x32x16_bf16 v[84:99], v[44:47], v[24:27], v[116:131]
    v_exp_f32 v100, v100
    v_exp_f32 v101, v101
    v_exp_f32 v102, v102
    v_exp_f32 v103, v103
    v_mfma_f32_32x32x16_bf16 v[148:163], v[68:71], v[76:79], v[148:163]
    v_exp_f32 v104, v104
    v_exp_f32 v105, v105
    v_exp_f32 v106, v106
    v_exp_f32 v107, v107
    v_cvt_pk_bf16_f32 v72, v100, v101
    v_cvt_pk_bf16_f32 v73, v102, v103
    v_cvt_pk_bf16_f32 v74, v104, v105
    v_cvt_pk_bf16_f32 v75, v106, v107
    v_mfma_f32_32x32x8_bf16 v[84:99], v[52:53], v[32:33], v[84:99]
    v_exp_f32 v108, v108
    v_exp_f32 v109, v109
    v_exp_f32 v110, v110
    v_exp_f32 v111, v111
    v_mfma_f32_32x32x16_bf16 v[164:179], v[60:63], v[72:75], v[164:179]
    v_exp_f32 v112, v112
    v_exp_f32 v113, v113
    v_exp_f32 v114, v114
    v_exp_f32 v115, v115
    v_cvt_pk_bf16_f32 v76, v108, v109
    v_cvt_pk_bf16_f32 v77, v110, v111
    v_cvt_pk_bf16_f32 v78, v112, v113
    v_cvt_pk_bf16_f32 v79, v114, v115
    v_mfma_f32_32x32x16_bf16 v[100:115], v[44:47], v[28:31], v[132:147]
    ds_read2st64_b64 v[48:51], v6 offset0:15 offset1:16
    ds_read_b64 v[54:55], v7 offset:9984
    v_exp_f32 v84, v84
    v_exp_f32 v85, v85
    v_exp_f32 v86, v86
    v_exp_f32 v87, v87
    v_mfma_f32_32x32x16_bf16 v[164:179], v[68:71], v[76:79], v[164:179]
    s_mov_b64 exec, s[22:23]
    ds_read_b128 v[64:67], v17 offset:8320
    ds_read_b128 v[60:63], v17 offset:8960
    s_mov_b64 exec, -1
    v_exp_f32 v88, v88
    v_exp_f32 v89, v89
    v_exp_f32 v90, v90
    v_exp_f32 v91, v91
    v_cvt_pk_bf16_f32 v72, v84, v85
    v_cvt_pk_bf16_f32 v73, v86, v87
    v_cvt_pk_bf16_f32 v74, v88, v89
    v_cvt_pk_bf16_f32 v75, v90, v91
    v_mfma_f32_32x32x8_bf16 v[100:115], v[52:53], v[34:35], v[100:115]
    v_exp_f32 v92, v92
    v_exp_f32 v93, v93
    v_exp_f32 v94, v94
    v_exp_f32 v95, v95
    v_mfma_f32_32x32x16_bf16 v[148:163], v[56:59], v[72:75], v[148:163]
    v_exp_f32 v96, v96
    v_exp_f32 v97, v97
    v_exp_f32 v98, v98
    v_exp_f32 v99, v99
    v_cvt_pk_bf16_f32 v76, v92, v93
    v_cvt_pk_bf16_f32 v77, v94, v95
    v_cvt_pk_bf16_f32 v78, v96, v97
    v_cvt_pk_bf16_f32 v79, v98, v99
    s_waitcnt lgkmcnt(0)
    v_mfma_f32_32x32x16_bf16 v[84:99], v[48:51], v[24:27], v[116:131]
    v_exp_f32 v100, v100
    v_exp_f32 v101, v101
    v_exp_f32 v102, v102
    v_exp_f32 v103, v103
    v_mfma_f32_32x32x16_bf16 v[148:163], v[64:67], v[76:79], v[148:163]
    v_exp_f32 v104, v104
    v_exp_f32 v105, v105
    v_exp_f32 v106, v106
    v_exp_f32 v107, v107
    v_cvt_pk_bf16_f32 v72, v100, v101
    v_cvt_pk_bf16_f32 v73, v102, v103
    v_cvt_pk_bf16_f32 v74, v104, v105
    v_cvt_pk_bf16_f32 v75, v106, v107
    v_mfma_f32_32x32x8_bf16 v[84:99], v[54:55], v[32:33], v[84:99]
    v_exp_f32 v108, v108
    v_exp_f32 v109, v109
    v_exp_f32 v110, v110
    v_exp_f32 v111, v111
    v_mfma_f32_32x32x16_bf16 v[164:179], v[56:59], v[72:75], v[164:179]
    v_exp_f32 v112, v112
    v_exp_f32 v113, v113
    v_exp_f32 v114, v114
    v_exp_f32 v115, v115
    v_cvt_pk_bf16_f32 v76, v108, v109
    v_cvt_pk_bf16_f32 v77, v110, v111
    v_cvt_pk_bf16_f32 v78, v112, v113
    v_cvt_pk_bf16_f32 v79, v114, v115
    v_mfma_f32_32x32x16_bf16 v[100:115], v[48:51], v[28:31], v[132:147]
    ds_read2st64_b64 v[44:47], v5 offset0:40 offset1:41
    ds_read_b64 v[52:53], v7 offset:21504
    v_exp_f32 v84, v84
    v_exp_f32 v85, v85
    v_exp_f32 v86, v86
    v_exp_f32 v87, v87
    v_mfma_f32_32x32x16_bf16 v[164:179], v[64:67], v[76:79], v[164:179]
    s_mov_b64 exec, s[22:23]
    ds_read_b128 v[68:71], v17 offset:9600
    ds_read_b128 v[56:59], v17 offset:20480
    s_mov_b64 exec, -1
    v_exp_f32 v88, v88
    v_exp_f32 v89, v89
    v_exp_f32 v90, v90
    v_exp_f32 v91, v91
    v_cvt_pk_bf16_f32 v72, v84, v85
    v_cvt_pk_bf16_f32 v73, v86, v87
    v_cvt_pk_bf16_f32 v74, v88, v89
    v_cvt_pk_bf16_f32 v75, v90, v91
    v_mfma_f32_32x32x8_bf16 v[100:115], v[54:55], v[34:35], v[100:115]
    v_exp_f32 v92, v92
    v_exp_f32 v93, v93
    v_exp_f32 v94, v94
    v_exp_f32 v95, v95
    v_mfma_f32_32x32x16_bf16 v[148:163], v[60:63], v[72:75], v[148:163]
    v_exp_f32 v96, v96
    v_exp_f32 v97, v97
    v_exp_f32 v98, v98
    v_exp_f32 v99, v99
    v_cvt_pk_bf16_f32 v76, v92, v93
    v_cvt_pk_bf16_f32 v77, v94, v95
    v_cvt_pk_bf16_f32 v78, v96, v97
    v_cvt_pk_bf16_f32 v79, v98, v99
    s_waitcnt lgkmcnt(0)
    v_mfma_f32_32x32x16_bf16 v[84:99], v[44:47], v[24:27], v[116:131]
    v_exp_f32 v100, v100
    v_exp_f32 v101, v101
    v_exp_f32 v102, v102
    v_exp_f32 v103, v103
    v_mfma_f32_32x32x16_bf16 v[148:163], v[68:71], v[76:79], v[148:163]
    v_exp_f32 v104, v104
    v_exp_f32 v105, v105
    v_exp_f32 v106, v106
    v_exp_f32 v107, v107
    v_cvt_pk_bf16_f32 v72, v100, v101
    v_cvt_pk_bf16_f32 v73, v102, v103
    v_cvt_pk_bf16_f32 v74, v104, v105
    v_cvt_pk_bf16_f32 v75, v106, v107
    v_mfma_f32_32x32x8_bf16 v[84:99], v[52:53], v[32:33], v[84:99]
    v_exp_f32 v108, v108
    v_exp_f32 v109, v109
    v_exp_f32 v110, v110
    v_exp_f32 v111, v111
    v_mfma_f32_32x32x16_bf16 v[164:179], v[60:63], v[72:75], v[164:179]
    v_exp_f32 v112, v112
    v_exp_f32 v113, v113
    v_exp_f32 v114, v114
    v_exp_f32 v115, v115
    v_cvt_pk_bf16_f32 v76, v108, v109
    v_cvt_pk_bf16_f32 v77, v110, v111
    v_cvt_pk_bf16_f32 v78, v112, v113
    v_cvt_pk_bf16_f32 v79, v114, v115
    v_add_u32 v5, 20480, v5
    v_add_u32 v6, 20480, v6
    v_add_u32 v7, 20480, v7
    v_add_u32 v17, 20480, v17
    s_add_u32 s20, s20, 1
    s_cmp_lt_u32 s20, 4
    s_cbranch_scc1 K2_RLOOP
    s_branch K2_LOOPEND
K2_DONE:
K2_END:
    s_endpgm
.p2align 4
K2_TABLE:
    .long 0xf149f2ca, 0xf149f2ca, 0x0, 0xf149f2ca, 0xf149f2ca, 0xf149f2ca, 0xf149f2ca, 0x0
    .long 0xf149f2ca, 0xf149f2ca, 0xf149f2ca, 0xf149f2ca, 0xf149f2ca, 0xf149f2ca, 0xf149f2ca, 0xf149f2ca
    .long 0xf149f2ca, 0xf149f2ca, 0xf149f2ca, 0xf149f2ca, 0xf149f2ca, 0xf149f2ca, 0xf149f2ca, 0xf149f2ca
    .long 0xf149f2ca, 0xf149f2ca, 0xf149f2ca, 0xf149f2ca, 0xf149f2ca, 0xf149f2ca, 0xf149f2ca, 0xf149f2ca
    .long 0xf149f2ca, 0xf149f2ca, 0xf149f2ca, 0xf149f2ca, 0xf149f2ca, 0xf149f2ca, 0xf149f2ca, 0xf149f2ca
    .long 0xf149f2ca, 0xf149f2ca, 0xf149f2ca, 0xf149f2ca, 0xf149f2ca, 0xf149f2ca, 0xf149f2ca, 0xf149f2ca
    .long 0xf149f2ca, 0xf149f2ca, 0xf149f2ca, 0xf149f2ca, 0xf149f2ca, 0xf149f2ca, 0xf149f2ca, 0xf149f2ca
    .long 0xf149f2ca, 0xf149f2ca, 0xf149f2ca, 0xf149f2ca, 0xf149f2ca, 0xf149f2ca, 0xf149f2ca, 0xf149f2ca
    .long 0xf149f2ca, 0xf149f2ca, 0xf149f2ca, 0xf149f2ca, 0xf149f2ca, 0xf149f2ca, 0xf149f2ca, 0xf149f2ca
    .long 0xf149f2ca, 0xf149f2ca, 0xf149f2ca, 0xf149f2ca, 0xf149f2ca, 0xf149f2ca, 0xf149f2ca, 0xf149f2ca
    .long 0xf149f2ca, 0xf149f2ca, 0xf149f2ca, 0xf149f2ca, 0xf149f2ca, 0xf149f2ca, 0xf149f2ca, 0xf149f2ca
    .long 0xf149f2ca, 0xf149f2ca, 0xf149f2ca, 0xf149f2ca, 0xf149f2ca, 0xf149f2ca, 0xf149f2ca, 0xf149f2ca
    .long 0xf149f2ca, 0xf149f2ca, 0xf149f2ca, 0xf149f2ca, 0xf149f2ca, 0xf149f2ca, 0xf149f2ca, 0xf149f2ca
    .long 0xf149f2ca, 0xf149f2ca, 0xf149f2ca, 0xf149f2ca, 0xf149f2ca, 0xf149f2ca, 0xf149f2ca, 0xf149f2ca
    .long 0xf149f2ca, 0xf149f2ca, 0xf149f2ca, 0xf149f2ca, 0xf149f2ca, 0xf149f2ca, 0xf149f2ca, 0xf149f2ca
    .long 0xf149f2ca, 0xf149f2ca, 0xf149f2ca, 0xf149f2ca, 0xf149f2ca, 0xf149f2ca, 0xf149f2ca, 0xf149f2ca
    .long 0x0, 0xf149f2ca, 0x0, 0xf149f2ca, 0xf149f2ca, 0x0, 0xf149f2ca, 0x0
    .long 0x0, 0xf149f2ca, 0x0, 0xf149f2ca, 0xf149f2ca, 0x0, 0xf149f2ca, 0x0
    .long 0xf149f2ca, 0xf149f2ca, 0x0, 0xf149f2ca, 0xf149f2ca, 0xf149f2ca, 0xf149f2ca, 0x0
    .long 0xf149f2ca, 0xf149f2ca, 0xf149f2ca, 0xf149f2ca, 0xf149f2ca, 0xf149f2ca, 0xf149f2ca, 0xf149f2ca
    .long 0xf149f2ca, 0xf149f2ca, 0xf149f2ca, 0xf149f2ca, 0xf149f2ca, 0xf149f2ca, 0xf149f2ca, 0xf149f2ca
    .long 0xf149f2ca, 0xf149f2ca, 0xf149f2ca, 0xf149f2ca, 0xf149f2ca, 0xf149f2ca, 0xf149f2ca, 0xf149f2ca
    .long 0xf149f2ca, 0xf149f2ca, 0xf149f2ca, 0xf149f2ca, 0xf149f2ca, 0xf149f2ca, 0xf149f2ca, 0xf149f2ca
    .long 0xf149f2ca, 0xf149f2ca, 0xf149f2ca, 0xf149f2ca, 0xf149f2ca, 0xf149f2ca, 0xf149f2ca, 0xf149f2ca
    .long 0xf149f2ca, 0xf149f2ca, 0xf149f2ca, 0xf149f2ca, 0xf149f2ca, 0xf149f2ca, 0xf149f2ca, 0xf149f2ca
    .long 0xf149f2ca, 0xf149f2ca, 0xf149f2ca, 0xf149f2ca, 0xf149f2ca, 0xf149f2ca, 0xf149f2ca, 0xf149f2ca
    .long 0xf149f2ca, 0xf149f2ca, 0xf149f2ca, 0xf149f2ca, 0xf149f2ca, 0xf149f2ca, 0xf149f2ca, 0xf149f2ca
    .long 0xf149f2ca, 0xf149f2ca, 0xf149f2ca, 0xf149f2ca, 0xf149f2ca, 0xf149f2ca, 0xf149f2ca, 0xf149f2ca
    .long 0xf149f2ca, 0xf149f2ca, 0xf149f2ca, 0xf149f2ca, 0xf149f2ca, 0xf149f2ca, 0xf149f2ca, 0xf149f2ca
    .long 0xf149f2ca, 0xf149f2ca, 0xf149f2ca, 0xf149f2ca, 0xf149f2ca, 0xf149f2ca, 0xf149f2ca, 0xf149f2ca
    .long 0xf149f2ca, 0xf149f2ca, 0xf149f2ca, 0xf149f2ca, 0xf149f2ca, 0xf149f2ca, 0xf149f2ca, 0xf149f2ca
    .long 0xf149f2ca, 0xf149f2ca, 0xf149f2ca, 0xf149f2ca, 0xf149f2ca, 0xf149f2ca, 0xf149f2ca, 0xf149f2ca
    .long 0x0, 0xf149f2ca, 0x0, 0xf149f2ca, 0xf149f2ca, 0x0, 0xf149f2ca, 0x0
    .long 0x0, 0xf149f2ca, 0x0, 0xf149f2ca, 0xf149f2ca, 0x0, 0xf149f2ca, 0x0
    .long 0x0, 0xf149f2ca, 0x0, 0xf149f2ca, 0xf149f2ca, 0x0, 0xf149f2ca, 0x0
    .long 0x0, 0xf149f2ca, 0x0, 0xf149f2ca, 0xf149f2ca, 0x0, 0xf149f2ca, 0x0
    .long 0xf149f2ca, 0xf149f2ca, 0x0, 0xf149f2ca, 0xf149f2ca, 0xf149f2ca, 0xf149f2ca, 0x0
    .long 0xf149f2ca, 0xf149f2ca, 0xf149f2ca, 0xf149f2ca, 0xf149f2ca, 0xf149f2ca, 0xf149f2ca, 0xf149f2ca
    .long 0xf149f2ca, 0xf149f2ca, 0xf149f2ca, 0xf149f2ca, 0xf149f2ca, 0xf149f2ca, 0xf149f2ca, 0xf149f2ca
    .long 0xf149f2ca, 0xf149f2ca, 0xf149f2ca, 0xf149f2ca, 0xf149f2ca, 0xf149f2ca, 0xf149f2ca, 0xf149f2ca
    .long 0xf149f2ca, 0xf149f2ca, 0xf149f2ca, 0xf149f2ca, 0xf149f2ca, 0xf149f2ca, 0xf149f2ca, 0xf149f2ca
    .long 0xf149f2ca, 0xf149f2ca, 0xf149f2ca, 0xf149f2ca, 0xf149f2ca, 0xf149f2ca, 0xf149f2ca, 0xf149f2ca
    .long 0xf149f2ca, 0xf149f2ca, 0xf149f2ca, 0xf149f2ca, 0xf149f2ca, 0xf149f2ca, 0xf149f2ca, 0xf149f2ca
    .long 0xf149f2ca, 0xf149f2ca, 0xf149f2ca, 0xf149f2ca, 0xf149f2ca, 0xf149f2ca, 0xf149f2ca, 0xf149f2ca
    .long 0xf149f2ca, 0xf149f2ca, 0xf149f2ca, 0xf149f2ca, 0xf149f2ca, 0xf149f2ca, 0xf149f2ca, 0xf149f2ca
    .long 0xf149f2ca, 0xf149f2ca, 0xf149f2ca, 0xf149f2ca, 0xf149f2ca, 0xf149f2ca, 0xf149f2ca, 0xf149f2ca
    .long 0xf149f2ca, 0xf149f2ca, 0xf149f2ca, 0xf149f2ca, 0xf149f2ca, 0xf149f2ca, 0xf149f2ca, 0xf149f2ca
    .long 0xf149f2ca, 0xf149f2ca, 0xf149f2ca, 0xf149f2ca, 0xf149f2ca, 0xf149f2ca, 0xf149f2ca, 0xf149f2ca
    .long 0x0, 0xf149f2ca, 0x0, 0xf149f2ca, 0xf149f2ca, 0x0, 0xf149f2ca, 0x0
    .long 0x0, 0xf149f2ca, 0x0, 0xf149f2ca, 0xf149f2ca, 0x0, 0xf149f2ca, 0x0
    .long 0x0, 0xf149f2ca, 0x0, 0xf149f2ca, 0xf149f2ca, 0x0, 0xf149f2ca, 0x0
    .long 0x0, 0xf149f2ca, 0x0, 0xf149f2ca, 0xf149f2ca, 0x0, 0xf149f2ca, 0x0
    .long 0x0, 0xf149f2ca, 0x0, 0xf149f2ca, 0xf149f2ca, 0x0, 0xf149f2ca, 0x0
    .long 0x0, 0xf149f2ca, 0x0, 0xf149f2ca, 0xf149f2ca, 0x0, 0xf149f2ca, 0x0
    .long 0xf149f2ca, 0xf149f2ca, 0x0, 0xf149f2ca, 0xf149f2ca, 0xf149f2ca, 0xf149f2ca, 0x0
    .long 0xf149f2ca, 0xf149f2ca, 0xf149f2ca, 0xf149f2ca, 0xf149f2ca, 0xf149f2ca, 0xf149f2ca, 0xf149f2ca
    .long 0xf149f2ca, 0xf149f2ca, 0xf149f2ca, 0xf149f2ca, 0xf149f2ca, 0xf149f2ca, 0xf149f2ca, 0xf149f2ca
    .long 0xf149f2ca, 0xf149f2ca, 0xf149f2ca, 0xf149f2ca, 0xf149f2ca, 0xf149f2ca, 0xf149f2ca, 0xf149f2ca
    .long 0xf149f2ca, 0xf149f2ca, 0xf149f2ca, 0xf149f2ca, 0xf149f2ca, 0xf149f2ca, 0xf149f2ca, 0xf149f2ca
    .long 0xf149f2ca, 0xf149f2ca, 0xf149f2ca, 0xf149f2ca, 0xf149f2ca, 0xf149f2ca, 0xf149f2ca, 0xf149f2ca
    .long 0xf149f2ca, 0xf149f2ca, 0xf149f2ca, 0xf149f2ca, 0xf149f2ca, 0xf149f2ca, 0xf149f2ca, 0xf149f2ca
    .long 0xf149f2ca, 0xf149f2ca, 0xf149f2ca, 0xf149f2ca, 0xf149f2ca, 0xf149f2ca, 0xf149f2ca, 0xf149f2ca
    .long 0xf149f2ca, 0xf149f2ca, 0xf149f2ca, 0xf149f2ca, 0xf149f2ca, 0xf149f2ca, 0xf149f2ca, 0xf149f2ca
    .long 0xf149f2ca, 0xf149f2ca, 0xf149f2ca, 0xf149f2ca, 0xf149f2ca, 0xf149f2ca, 0xf149f2ca, 0xf149f2ca
    .long 0x0, 0xf149f2ca, 0xf149f2ca, 0xf149f2ca, 0xf149f2ca, 0x0, 0xf149f2ca, 0xf149f2ca
    .long 0x0, 0xf149f2ca, 0x0, 0xf149f2ca, 0xf149f2ca, 0x0, 0xf149f2ca, 0x0
    .long 0x0, 0xf149f2ca, 0x0, 0xf149f2ca, 0xf149f2ca, 0x0, 0xf149f2ca, 0x0
    .long 0x0, 0xf149f2ca, 0x0, 0xf149f2ca, 0xf149f2ca, 0x0, 0xf149f2ca, 0x0
    .long 0x0, 0xf149f2ca, 0x0, 0xf149f2ca, 0xf149f2ca, 0x0, 0xf149f2ca, 0x0
    .long 0x0, 0xf149f2ca, 0x0, 0xf149f2ca, 0xf149f2ca, 0x0, 0xf149f2ca, 0x0
    .long 0x0, 0xf149f2ca, 0x0, 0xf149f2ca, 0xf149f2ca, 0x0, 0xf149f2ca, 0x0
    .long 0x0, 0xf149f2ca, 0x0, 0xf149f2ca, 0xf149f2ca, 0x0, 0xf149f2ca, 0x0
    .long 0xf149f2ca, 0xf149f2ca, 0x0, 0xf149f2ca, 0xf149f2ca, 0xf149f2ca, 0xf149f2ca, 0x0
    .long 0xf149f2ca, 0xf149f2ca, 0xf149f2ca, 0xf149f2ca, 0xf149f2ca, 0xf149f2ca, 0xf149f2ca, 0xf149f2ca
    .long 0xf149f2ca, 0xf149f2ca, 0xf149f2ca, 0xf149f2ca, 0xf149f2ca, 0xf149f2ca, 0xf149f2ca, 0xf149f2ca
    .long 0xf149f2ca, 0xf149f2ca, 0xf149f2ca, 0xf149f2ca, 0xf149f2ca, 0xf149f2ca, 0xf149f2ca, 0xf149f2ca
    .long 0xf149f2ca, 0xf149f2ca, 0xf149f2ca, 0xf149f2ca, 0xf149f2ca, 0xf149f2ca, 0xf149f2ca, 0xf149f2ca
    .long 0xf149f2ca, 0xf149f2ca, 0xf149f2ca, 0xf149f2ca, 0xf149f2ca, 0xf149f2ca, 0xf149f2ca, 0xf149f2ca
    .long 0xf149f2ca, 0xf149f2ca, 0xf149f2ca, 0xf149f2ca, 0xf149f2ca, 0xf149f2ca, 0xf149f2ca, 0xf149f2ca
    .long 0xf149f2ca, 0xf149f2ca, 0xf149f2ca, 0xf149f2ca, 0xf149f2ca, 0xf149f2ca, 0xf149f2ca, 0xf149f2ca
    .long 0xf149f2ca, 0xf149f2ca, 0xf149f2ca, 0xf149f2ca, 0xf149f2ca, 0xf149f2ca, 0xf149f2ca, 0xf149f2ca
    .long 0xf149f2ca, 0xf149f2ca, 0xf149f2ca, 0xf149f2ca, 0xf149f2ca, 0xf149f2ca, 0xf149f2ca, 0xf149f2ca
    .long 0x0, 0xf149f2ca, 0xf149f2ca, 0xf149f2ca, 0xf149f2ca, 0x0, 0xf149f2ca, 0xf149f2ca
    .long 0x0, 0xf149f2ca, 0x0, 0xf149f2ca, 0xf149f2ca, 0x0, 0xf149f2ca, 0x0
    .long 0x0, 0xf149f2ca, 0x0, 0xf149f2ca, 0xf149f2ca, 0x0, 0xf149f2ca, 0x0
    .long 0x0, 0xf149f2ca, 0x0, 0xf149f2ca, 0xf149f2ca, 0x0, 0xf149f2ca, 0x0
    .long 0x0, 0xf149f2ca, 0x0, 0xf149f2ca, 0xf149f2ca, 0x0, 0xf149f2ca, 0x0
    .long 0x0, 0xf149f2ca, 0x0, 0xf149f2ca, 0xf149f2ca, 0x0, 0xf149f2ca, 0x0
    .long 0x0, 0xf149f2ca, 0x0, 0xf149f2ca, 0xf149f2ca, 0x0, 0xf149f2ca, 0x0
    .long 0x0, 0xf149f2ca, 0x0, 0xf149f2ca, 0xf149f2ca, 0x0, 0xf149f2ca, 0x0
    .long 0xf149f2ca, 0xf149f2ca, 0x0, 0xf149f2ca, 0xf149f2ca, 0xf149f2ca, 0xf149f2ca, 0x0
    .long 0xf149f2ca, 0xf149f2ca, 0xf149f2ca, 0xf149f2ca, 0xf149f2ca, 0xf149f2ca, 0xf149f2ca, 0xf149f2ca
    .long 0xf149f2ca, 0xf149f2ca, 0xf149f2ca, 0xf149f2ca, 0xf149f2ca, 0xf149f2ca, 0xf149f2ca, 0xf149f2ca
    .long 0xf149f2ca, 0xf149f2ca, 0xf149f2ca, 0xf149f2ca, 0xf149f2ca, 0xf149f2ca, 0xf149f2ca, 0xf149f2ca
    .long 0xf149f2ca, 0xf149f2ca, 0xf149f2ca, 0xf149f2ca, 0xf149f2ca, 0xf149f2ca, 0xf149f2ca, 0xf149f2ca
    .long 0xf149f2ca, 0xf149f2ca, 0xf149f2ca, 0xf149f2ca, 0xf149f2ca, 0xf149f2ca, 0xf149f2ca, 0xf149f2ca
    .long 0xf149f2ca, 0xf149f2ca, 0xf149f2ca, 0xf149f2ca, 0xf149f2ca, 0xf149f2ca, 0xf149f2ca, 0xf149f2ca
    .long 0xf149f2ca, 0xf149f2ca, 0xf149f2ca, 0xf149f2ca, 0xf149f2ca, 0xf149f2ca, 0xf149f2ca, 0xf149f2ca
    .long 0xf149f2ca, 0xf149f2ca, 0xf149f2ca, 0xf149f2ca, 0xf149f2ca, 0xf149f2ca, 0xf149f2ca, 0xf149f2ca
    .long 0xf149f2ca, 0xf149f2ca, 0xf149f2ca, 0xf149f2ca, 0xf149f2ca, 0xf149f2ca, 0xf149f2ca, 0xf149f2ca
    .long 0x0, 0xf149f2ca, 0xf149f2ca, 0xf149f2ca, 0xf149f2ca, 0x0, 0xf149f2ca, 0xf149f2ca
    .long 0x0, 0xf149f2ca, 0x0, 0xf149f2ca, 0xf149f2ca, 0x0, 0xf149f2ca, 0x0
    .long 0x0, 0xf149f2ca, 0x0, 0xf149f2ca, 0xf149f2ca, 0x0, 0xf149f2ca, 0x0
    .long 0x0, 0xf149f2ca, 0x0, 0xf149f2ca, 0xf149f2ca, 0x0, 0xf149f2ca, 0x0
    .long 0x0, 0xf149f2ca, 0x0, 0xf149f2ca, 0xf149f2ca, 0x0, 0xf149f2ca, 0x0
    .long 0x0, 0xf149f2ca, 0x0, 0xf149f2ca, 0xf149f2ca, 0x0, 0xf149f2ca, 0x0
    .long 0x0, 0xf149f2ca, 0x0, 0xf149f2ca, 0xf149f2ca, 0x0, 0xf149f2ca, 0x0
    .long 0x0, 0xf149f2ca, 0x0, 0xf149f2ca, 0xf149f2ca, 0x0, 0xf149f2ca, 0x0
    .long 0xf149f2ca, 0xf149f2ca, 0x0, 0xf149f2ca, 0xf149f2ca, 0xf149f2ca, 0xf149f2ca, 0x0
    .long 0xf149f2ca, 0xf149f2ca, 0xf149f2ca, 0xf149f2ca, 0xf149f2ca, 0xf149f2ca, 0xf149f2ca, 0xf149f2ca
    .long 0xf149f2ca, 0xf149f2ca, 0xf149f2ca, 0xf149f2ca, 0xf149f2ca, 0xf149f2ca, 0xf149f2ca, 0xf149f2ca
    .long 0xf149f2ca, 0xf149f2ca, 0xf149f2ca, 0xf149f2ca, 0xf149f2ca, 0xf149f2ca, 0xf149f2ca, 0xf149f2ca
    .long 0xf149f2ca, 0xf149f2ca, 0xf149f2ca, 0xf149f2ca, 0xf149f2ca, 0xf149f2ca, 0xf149f2ca, 0xf149f2ca
    .long 0xf149f2ca, 0xf149f2ca, 0xf149f2ca, 0xf149f2ca, 0xf149f2ca, 0xf149f2ca, 0xf149f2ca, 0xf149f2ca
    .long 0xf149f2ca, 0xf149f2ca, 0xf149f2ca, 0xf149f2ca, 0xf149f2ca, 0xf149f2ca, 0xf149f2ca, 0xf149f2ca
    .long 0xf149f2ca, 0xf149f2ca, 0xf149f2ca, 0xf149f2ca, 0xf149f2ca, 0xf149f2ca, 0xf149f2ca, 0xf149f2ca
    .long 0xf149f2ca, 0xf149f2ca, 0xf149f2ca, 0xf149f2ca, 0xf149f2ca, 0xf149f2ca, 0xf149f2ca, 0xf149f2ca
    .long 0xf149f2ca, 0xf149f2ca, 0xf149f2ca, 0xf149f2ca, 0xf149f2ca, 0xf149f2ca, 0xf149f2ca, 0xf149f2ca
    .long 0x0, 0xf149f2ca, 0xf149f2ca, 0xf149f2ca, 0xf149f2ca, 0x0, 0xf149f2ca, 0xf149f2ca
    .long 0x0, 0xf149f2ca, 0x0, 0xf149f2ca, 0xf149f2ca, 0x0, 0xf149f2ca, 0x0
    .long 0x0, 0xf149f2ca, 0x0, 0xf149f2ca, 0xf149f2ca, 0x0, 0xf149f2ca, 0x0
    .long 0x0, 0xf149f2ca, 0x0, 0xf149f2ca, 0xf149f2ca, 0x0, 0xf149f2ca, 0x0
    .long 0x0, 0xf149f2ca, 0x0, 0xf149f2ca, 0xf149f2ca, 0x0, 0xf149f2ca, 0x0
    .long 0x0, 0xf149f2ca, 0x0, 0xf149f2ca, 0xf149f2ca, 0x0, 0xf149f2ca, 0x0
    .long 0x0, 0xf149f2ca, 0x0, 0xf149f2ca, 0xf149f2ca, 0x0, 0xf149f2ca, 0x0
    .long 0x0, 0xf149f2ca, 0x0, 0xf149f2ca, 0xf149f2ca, 0x0, 0xf149f2ca, 0x0
    .long 0xf149f2ca, 0xf149f2ca, 0x0, 0xf149f2ca, 0xf149f2ca, 0xf149f2ca, 0xf149f2ca, 0x0
    .long 0xf149f2ca, 0xf149f2ca, 0xf149f2ca, 0xf149f2ca, 0xf149f2ca, 0xf149f2ca, 0xf149f2ca, 0xf149f2ca
    .long 0xf149f2ca, 0xf149f2ca, 0xf149f2ca, 0xf149f2ca, 0xf149f2ca, 0xf149f2ca, 0xf149f2ca, 0xf149f2ca
    .long 0xf149f2ca, 0xf149f2ca, 0xf149f2ca, 0xf149f2ca, 0xf149f2ca, 0xf149f2ca, 0xf149f2ca, 0xf149f2ca
    .long 0xf149f2ca, 0xf149f2ca, 0xf149f2ca, 0xf149f2ca, 0xf149f2ca, 0xf149f2ca, 0xf149f2ca, 0xf149f2ca
    .long 0xf149f2ca, 0xf149f2ca, 0xf149f2ca, 0xf149f2ca, 0xf149f2ca, 0xf149f2ca, 0xf149f2ca, 0xf149f2ca
    .long 0xf149f2ca, 0xf149f2ca, 0xf149f2ca, 0xf149f2ca, 0xf149f2ca, 0xf149f2ca, 0xf149f2ca, 0xf149f2ca
    .long 0xf149f2ca, 0xf149f2ca, 0xf149f2ca, 0xf149f2ca, 0xf149f2ca, 0xf149f2ca, 0xf149f2ca, 0xf149f2ca
    .long 0xf149f2ca, 0xf149f2ca, 0xf149f2ca, 0xf149f2ca, 0xf149f2ca, 0xf149f2ca, 0xf149f2ca, 0xf149f2ca
    .long 0xf149f2ca, 0xf149f2ca, 0xf149f2ca, 0xf149f2ca, 0xf149f2ca, 0xf149f2ca, 0xf149f2ca, 0xf149f2ca
    .long 0x0, 0xf149f2ca, 0xf149f2ca, 0xf149f2ca, 0xf149f2ca, 0x0, 0xf149f2ca, 0xf149f2ca
    .long 0x0, 0xf149f2ca, 0x0, 0xf149f2ca, 0xf149f2ca, 0x0, 0xf149f2ca, 0x0
    .long 0x0, 0xf149f2ca, 0x0, 0xf149f2ca, 0xf149f2ca, 0x0, 0xf149f2ca, 0x0
    .long 0x0, 0xf149f2ca, 0x0, 0xf149f2ca, 0xf149f2ca, 0x0, 0xf149f2ca, 0x0
    .long 0x0, 0xf149f2ca, 0x0, 0xf149f2ca, 0xf149f2ca, 0x0, 0xf149f2ca, 0x0
    .long 0x0, 0xf149f2ca, 0x0, 0xf149f2ca, 0xf149f2ca, 0x0, 0xf149f2ca, 0x0
    .long 0x0, 0xf149f2ca, 0x0, 0xf149f2ca, 0xf149f2ca, 0x0, 0xf149f2ca, 0x0
    .long 0x0, 0xf149f2ca, 0x0, 0xf149f2ca, 0xf149f2ca, 0x0, 0xf149f2ca, 0x0
    .long 0xf149f2ca, 0xf149f2ca, 0xf149f2ca, 0xf149f2ca, 0xf149f2ca, 0xf149f2ca, 0xf149f2ca, 0xf149f2ca
    .long 0xf149f2ca, 0xf149f2ca, 0xf149f2ca, 0xf149f2ca, 0xf149f2ca, 0xf149f2ca, 0xf149f2ca, 0xf149f2ca
    .long 0xf149f2ca, 0xf149f2ca, 0xf149f2ca, 0xf149f2ca, 0xf149f2ca, 0xf149f2ca, 0xf149f2ca, 0xf149f2ca
    .long 0xf149f2ca, 0xf149f2ca, 0xf149f2ca, 0xf149f2ca, 0xf149f2ca, 0xf149f2ca, 0xf149f2ca, 0xf149f2ca
    .long 0xf149f2ca, 0xf149f2ca, 0xf149f2ca, 0xf149f2ca, 0xf149f2ca, 0xf149f2ca, 0xf149f2ca, 0xf149f2ca
    .long 0xf149f2ca, 0xf149f2ca, 0xf149f2ca, 0xf149f2ca, 0xf149f2ca, 0xf149f2ca, 0xf149f2ca, 0xf149f2ca
    .long 0xf149f2ca, 0xf149f2ca, 0xf149f2ca, 0xf149f2ca, 0xf149f2ca, 0xf149f2ca, 0xf149f2ca, 0xf149f2ca
    .long 0xf149f2ca, 0xf149f2ca, 0xf149f2ca, 0xf149f2ca, 0xf149f2ca, 0xf149f2ca, 0xf149f2ca, 0xf149f2ca
    .long 0xf149f2ca, 0xf149f2ca, 0xf149f2ca, 0xf149f2ca, 0xf149f2ca, 0xf149f2ca, 0xf149f2ca, 0xf149f2ca
    .long 0xf149f2ca, 0xf149f2ca, 0xf149f2ca, 0xf149f2ca, 0xf149f2ca, 0xf149f2ca, 0xf149f2ca, 0xf149f2ca
    .long 0x0, 0xf149f2ca, 0xf149f2ca, 0xf149f2ca, 0xf149f2ca, 0x0, 0xf149f2ca, 0xf149f2ca
    .long 0x0, 0xf149f2ca, 0x0, 0xf149f2ca, 0xf149f2ca, 0x0, 0xf149f2ca, 0x0
    .long 0x0, 0xf149f2ca, 0x0, 0xf149f2ca, 0xf149f2ca, 0x0, 0xf149f2ca, 0x0
    .long 0x0, 0xf149f2ca, 0x0, 0xf149f2ca, 0xf149f2ca, 0x0, 0xf149f2ca, 0x0
    .long 0x0, 0xf149f2ca, 0x0, 0xf149f2ca, 0xf149f2ca, 0x0, 0xf149f2ca, 0x0
    .long 0x0, 0xf149f2ca, 0x0, 0xf149f2ca, 0xf149f2ca, 0x0, 0xf149f2ca, 0x0
    .long 0xf149f2ca, 0xf149f2ca, 0xf149f2ca, 0xf149f2ca, 0xf149f2ca, 0xf149f2ca, 0xf149f2ca, 0xf149f2ca
    .long 0xf149f2ca, 0xf149f2ca, 0xf149f2ca, 0xf149f2ca, 0xf149f2ca, 0xf149f2ca, 0xf149f2ca, 0xf149f2ca
    .long 0xf149f2ca, 0xf149f2ca, 0xf149f2ca, 0xf149f2ca, 0xf149f2ca, 0xf149f2ca, 0xf149f2ca, 0xf149f2ca
    .long 0xf149f2ca, 0xf149f2ca, 0xf149f2ca, 0xf149f2ca, 0xf149f2ca, 0xf149f2ca, 0xf149f2ca, 0xf149f2ca
    .long 0xf149f2ca, 0xf149f2ca, 0xf149f2ca, 0xf149f2ca, 0xf149f2ca, 0xf149f2ca, 0xf149f2ca, 0xf149f2ca
    .long 0xf149f2ca, 0xf149f2ca, 0xf149f2ca, 0xf149f2ca, 0xf149f2ca, 0xf149f2ca, 0xf149f2ca, 0xf149f2ca
    .long 0xf149f2ca, 0xf149f2ca, 0xf149f2ca, 0xf149f2ca, 0xf149f2ca, 0xf149f2ca, 0xf149f2ca, 0xf149f2ca
    .long 0xf149f2ca, 0xf149f2ca, 0xf149f2ca, 0xf149f2ca, 0xf149f2ca, 0xf149f2ca, 0xf149f2ca, 0xf149f2ca
    .long 0xf149f2ca, 0xf149f2ca, 0xf149f2ca, 0xf149f2ca, 0xf149f2ca, 0xf149f2ca, 0xf149f2ca, 0xf149f2ca
    .long 0xf149f2ca, 0xf149f2ca, 0xf149f2ca, 0xf149f2ca, 0xf149f2ca, 0xf149f2ca, 0xf149f2ca, 0xf149f2ca
    .long 0xf149f2ca, 0xf149f2ca, 0xf149f2ca, 0xf149f2ca, 0xf149f2ca, 0xf149f2ca, 0xf149f2ca, 0xf149f2ca
    .long 0xf149f2ca, 0xf149f2ca, 0xf149f2ca, 0xf149f2ca, 0xf149f2ca, 0xf149f2ca, 0xf149f2ca, 0xf149f2ca
    .long 0x0, 0xf149f2ca, 0xf149f2ca, 0xf149f2ca, 0xf149f2ca, 0x0, 0xf149f2ca, 0xf149f2ca
    .long 0x0, 0xf149f2ca, 0x0, 0xf149f2ca, 0xf149f2ca, 0x0, 0xf149f2ca, 0x0
    .long 0x0, 0xf149f2ca, 0x0, 0xf149f2ca, 0xf149f2ca, 0x0, 0xf149f2ca, 0x0
    .long 0x0, 0xf149f2ca, 0x0, 0xf149f2ca, 0xf149f2ca, 0x0, 0xf149f2ca, 0x0
    .long 0xf149f2ca, 0xf149f2ca, 0xf149f2ca, 0xf149f2ca, 0xf149f2ca, 0xf149f2ca, 0xf149f2ca, 0xf149f2ca
    .long 0xf149f2ca, 0xf149f2ca, 0xf149f2ca, 0xf149f2ca, 0xf149f2ca, 0xf149f2ca, 0xf149f2ca, 0xf149f2ca
    .long 0xf149f2ca, 0xf149f2ca, 0xf149f2ca, 0xf149f2ca, 0xf149f2ca, 0xf149f2ca, 0xf149f2ca, 0xf149f2ca
    .long 0xf149f2ca, 0xf149f2ca, 0xf149f2ca, 0xf149f2ca, 0xf149f2ca, 0xf149f2ca, 0xf149f2ca, 0xf149f2ca
    .long 0xf149f2ca, 0xf149f2ca, 0xf149f2ca, 0xf149f2ca, 0xf149f2ca, 0xf149f2ca, 0xf149f2ca, 0xf149f2ca
    .long 0xf149f2ca, 0xf149f2ca, 0xf149f2ca, 0xf149f2ca, 0xf149f2ca, 0xf149f2ca, 0xf149f2ca, 0xf149f2ca
    .long 0xf149f2ca, 0xf149f2ca, 0xf149f2ca, 0xf149f2ca, 0xf149f2ca, 0xf149f2ca, 0xf149f2ca, 0xf149f2ca
    .long 0xf149f2ca, 0xf149f2ca, 0xf149f2ca, 0xf149f2ca, 0xf149f2ca, 0xf149f2ca, 0xf149f2ca, 0xf149f2ca
    .long 0xf149f2ca, 0xf149f2ca, 0xf149f2ca, 0xf149f2ca, 0xf149f2ca, 0xf149f2ca, 0xf149f2ca, 0xf149f2ca
    .long 0xf149f2ca, 0xf149f2ca, 0xf149f2ca, 0xf149f2ca, 0xf149f2ca, 0xf149f2ca, 0xf149f2ca, 0xf149f2ca
    .long 0xf149f2ca, 0xf149f2ca, 0xf149f2ca, 0xf149f2ca, 0xf149f2ca, 0xf149f2ca, 0xf149f2ca, 0xf149f2ca
    .long 0xf149f2ca, 0xf149f2ca, 0xf149f2ca, 0xf149f2ca, 0xf149f2ca, 0xf149f2ca, 0xf149f2ca, 0xf149f2ca
    .long 0xf149f2ca, 0xf149f2ca, 0xf149f2ca, 0xf149f2ca, 0xf149f2ca, 0xf149f2ca, 0xf149f2ca, 0xf149f2ca
    .long 0xf149f2ca, 0xf149f2ca, 0xf149f2ca, 0xf149f2ca, 0xf149f2ca, 0xf149f2ca, 0xf149f2ca, 0xf149f2ca
    .long 0x0, 0xf149f2ca, 0xf149f2ca, 0xf149f2ca, 0xf149f2ca, 0x0, 0xf149f2ca, 0xf149f2ca
    .long 0x0, 0xf149f2ca, 0x0, 0xf149f2ca, 0xf149f2ca, 0x0, 0xf149f2ca, 0x0
K2_TEXT_END:
.section .rodata,"a"
.p2align 6
.amdhsa_kernel k1_qkv_kernel
  .amdhsa_next_free_vgpr 184
  .amdhsa_next_free_sgpr 102
  .amdhsa_accum_offset 184
  .amdhsa_group_segment_fixed_size 0
  .amdhsa_kernarg_size 80
  .amdhsa_user_sgpr_count 2
  .amdhsa_user_sgpr_kernarg_segment_ptr 1
  .amdhsa_system_sgpr_workgroup_id_x 1
  .amdhsa_float_denorm_mode_32 3
  .amdhsa_float_denorm_mode_16_64 3
.end_amdhsa_kernel
.p2align 6
.amdhsa_kernel k2_attn_kernel
  .amdhsa_next_free_vgpr 248
  .amdhsa_next_free_sgpr 102
  .amdhsa_accum_offset 248
  .amdhsa_group_segment_fixed_size 0
  .amdhsa_kernarg_size 80
  .amdhsa_user_sgpr_count 2
  .amdhsa_user_sgpr_kernarg_segment_ptr 1
  .amdhsa_system_sgpr_workgroup_id_x 1
  .amdhsa_float_denorm_mode_32 3
  .amdhsa_float_denorm_mode_16_64 3
.end_amdhsa_kernel
```
